```python
import torch

def _softmax(x, axis=-1):
    return torch.softmax(x, dim=axis)
def _gelu(x):
    return torch.nn.functional.gelu(x, approximate="tanh")
def _silu(x):
    return torch.nn.functional.silu(x)
def _sigmoid(x):
    return torch.sigmoid(x)
def _layernorm(x, axis=-1, eps=1e-5):
    m = x.mean(dim=axis, keepdim=True)
    v = x.var(dim=axis, keepdim=True, unbiased=False)
    return (x - m) / torch.sqrt(v + eps)
def _scatter_add(tgt, idx, src, axis=0):
    return tgt.clone().index_add_(axis, idx, src)
def _segment_sum(src, seg, n):
    out = torch.zeros((n,) + src.shape[1:], dtype=src.dtype)
    return out.index_add_(0, seg, src)
def _pad(x, pw):
    flat = tuple(v for pair in reversed(pw) for v in pair)
    return torch.nn.functional.pad(x, flat)

kernel_name = 'parallel_sum__ssm_conv_s5__dense_activation_relu__prompt'

def setup_inputs():

    _w = (lambda a: (lambda t: t.to(torch.bfloat16) if t.is_floating_point() else t)(torch.as_tensor(a)))
    def _A_setup():
        B, S, D = 1, 2048, 640
        P = D
        Lambda_re = -0.5 * (lambda _x: torch.exp(torch.as_tensor(_x)))((lambda *s: torch.randn(*s, dtype=torch.bfloat16) * 0.8)(P))
        Lambda_im = (lambda *s: torch.randn(*s, dtype=torch.bfloat16) * 0.8)(P) * 1.0
        B_re = (lambda *s: torch.randn(*s, dtype=torch.bfloat16) * 0.8)(P, D) * (D ** -0.5)
        B_im = (lambda *s: torch.randn(*s, dtype=torch.bfloat16) * 0.8)(P, D) * (D ** -0.5)
        C_re = (lambda *s: torch.randn(*s, dtype=torch.bfloat16) * 0.8)(D, P) * (P ** -0.5)
        C_im = (lambda *s: torch.randn(*s, dtype=torch.bfloat16) * 0.8)(D, P) * (P ** -0.5)
        log_dt = (lambda *s: torch.randn(*s, dtype=torch.bfloat16) * 0.8)(P) * 0.3 - 2.0
        Dskip = (lambda *s: torch.randn(*s, dtype=torch.bfloat16) * 0.8)(D)
        return {
            "x": _w((lambda *s: torch.randn(*s, dtype=torch.bfloat16) * 0.05)(B, S, D)),
            "Lambda_re": _w(Lambda_re),
            "Lambda_im": _w(Lambda_im),
            "B_re": _w(B_re),
            "B_im": _w(B_im),
            "C_re": _w(C_re),
            "C_im": _w(C_im),
            "log_dt": _w(log_dt),
            "Dskip": _w(Dskip),
        }
    _A_in = _A_setup()

    def _B_setup():
        B, S, D, Dff = 1, 2048, 640, 1536
        return {
            "x": _w((lambda *s: torch.randn(*s, dtype=torch.bfloat16) * 0.05)(B, S, D)),
            "w1": _w((lambda *s: torch.randn(*s, dtype=torch.bfloat16) * 0.05)(D, Dff)),
            "w2": _w((lambda *s: torch.randn(*s, dtype=torch.bfloat16) * 0.05)(Dff, D)),
        }
    _B_in = _B_setup()

    return {
        "A_x": _A_in["x"],
        "A_Lambda_re": _A_in["Lambda_re"],
        "A_Lambda_im": _A_in["Lambda_im"],
        "A_B_re": _A_in["B_re"],
        "A_B_im": _A_in["B_im"],
        "A_C_re": _A_in["C_re"],
        "A_C_im": _A_in["C_im"],
        "A_log_dt": _A_in["log_dt"],
        "A_Dskip": _A_in["Dskip"],
        "B_x": _B_in["x"],
        "B_w1": _B_in["w1"],
        "B_w2": _B_in["w2"],
    }

def reference(A_x, A_Lambda_re, A_Lambda_im, A_B_re, A_B_im, A_C_re, A_C_im, A_log_dt, A_Dskip, B_x, B_w1, B_w2):
    def _A_ref(x, Lambda_re, Lambda_im, B_re, B_im, C_re, C_im, log_dt, Dskip):
        Bsz, L, H = x.shape
        Lam = Lambda_re + 1j * Lambda_im
        Bmat = B_re + 1j * B_im
        Cmat = C_re + 1j * C_im
        dt = torch.exp(log_dt)
        Lam_bar = torch.exp(dt * Lam)
        B_bar = ((Lam_bar - 1.0) / Lam)[:, None] * Bmat
        Bu = torch.einsum("bld,pd->blp", x + 0j, B_bar)
        h = torch.zeros_like(Bu[:, 0, :])
        hs = []
        for t in range(L):
            h = Lam_bar[None, :] * h + Bu[:, t, :]
            hs.append(h)
        hseq = torch.stack(hs, 1)
        y = 2.0 * torch.einsum("blp,dp->bld", hseq, Cmat).real + x * Dskip[None, None, :]
        return y

    def _B_ref(x, w1, w2):
        h = torch.einsum("bsd,df->bsf", x, w1)
        zero = torch.zeros_like(h)
        h = torch.maximum(h, zero)
        return torch.einsum("bsf,fd->bsd", h, w2)

    x = A_x
    xn = _layernorm(x, axis=-1)
    return x + _A_ref(xn, A_Lambda_re, A_Lambda_im, A_B_re, A_B_im, A_C_re, A_C_im, A_log_dt, A_Dskip) + _B_ref(xn, B_w1, B_w2)
```

```asm
; @launch grid=(256,1,1) block=(256,1,1) lds=154368
.amdgcn_target "amdgcn-amd-amdhsa--gfx950"
.text
.globl parallel_sum__ssm_conv_s5__dense_activation_relu__prompt_kernel
.p2align 8
.type parallel_sum__ssm_conv_s5__dense_activation_relu__prompt_kernel,@function
parallel_sum__ssm_conv_s5__dense_activation_relu__prompt_kernel:
    s_cmp_ge_u32 s2, 256
    s_cbranch_scc1 L_end
    s_load_dwordx16 s[36:51], s[0:1], 0
    s_load_dwordx8 s[52:59], s[0:1], 64
    s_load_dwordx4 s[60:63], s[0:1], 96
    s_load_dwordx2 s[64:65], s[0:1], 112
    s_getpc_b64 s[32:33]
L_pc:
    s_lshr_b32 s34, s2, 3
    s_lshl_b32 s34, s34, 10
    v_lshl_add_u32 v21, v0, 7, s34
    v_min_u32 v21, L_end-L_pc, v21
    v_cmp_gt_u32 vcc, 8, v0
    s_and_saveexec_b64 s[34:35], vcc
    s_cbranch_execz L_nopf
    global_load_dword v21, v21, s[32:33]
L_nopf:
    s_mov_b64 exec, -1
    v_lshrrev_b32 v1, 6, v0
    v_and_b32 v2, 63, v0
    v_and_b32 v6, 7, v0
    v_readfirstlane_b32 s27, v1
    v_lshrrev_b32 v4, 4, v2
    v_lshrrev_b32 v5, 3, v2
    s_bfe_u32 s28, s2, 0x20001
    s_lshl_b32 s28, s28, 2
    s_bfe_u32 s34, s2, 0x20003
    s_add_u32 s28, s28, s34
    s_lshl_b32 s32, s28, 7
    s_lshl_b32 s33, s27, 5
    s_add_u32 s32, s32, s33
    s_mul_i32 s76, s27, 7168
    s_mov_b32 m0, s76
    v_lshrrev_b32 v7, 2, v5
    v_and_b32 v8, 3, v5
    v_lshl_add_u32 v7, v7, 3, v8
    v_add_u32_e64 v7, s32, v7
    v_mul_u32_u24 v7, 1280, v7
    v_xor_b32_e64 v9, v4, v6
    v_lshl_add_u32 v10, v9, 4, v7
    v_xor_b32_e64 v8, 4, v9
    v_lshl_add_u32 v7, v8, 4, v7
    v_add_u32 v11, 19456, v7
    v_add_u32 v12, 3072, v10
    v_add_u32 v13, 22528, v7
    s_mov_b32 s6, 2621440
    s_mov_b32 s7, 0x20000
    s_and_b32 s29, s2, 1
    s_lshl_b32 s29, s29, 3
    s_lshr_b32 s34, s2, 5
    s_add_u32 s29, s29, s34
    s_and_b32 s33, s2, 7
    s_lshl_b32 s33, s33, 2
    s_lshr_b32 s33, 0x49168350, s33
    s_and_b32 s33, s33, 15
    s_bfe_u32 s34, s2, 0x20003
    s_add_u32 s33, s33, s34
    s_sub_u32 s34, s33, 10
    s_cselect_b32 s33, s33, s34
    s_lshl_b32 s20, s33, 7
    s_mov_b32 s23, s20
    s_waitcnt lgkmcnt(0)
    s_mov_b32 s4, s36
    s_mov_b32 s5, s37
    buffer_load_dwordx4 v10, s[4:7], s20 offen offset:0 lds
    s_mul_i32 s32, s29, 40
    s_lshr_b32 s33, s27, 1
    s_lshl_b32 s33, s33, 3
    s_add_u32 s32, s32, s33
    buffer_load_dwordx4 v11, s[4:7], s20 offen offset:1024 lds
    v_add_u32 v7, s32, v5
    v_mul_u32_u24 v7, 1280, v7
    s_and_b32 s34, s27, 1
    s_lshl_b32 s33, s34, 2
    buffer_load_dwordx4 v12, s[4:7], s20 offen offset:2048 lds
    v_xor_b32_e64 v8, s33, v9
    v_lshl_add_u32 v17, v8, 4, v7
    v_add_u32 v18, 19456, v17
    s_mov_b32 s30, 0x40000000
    s_cmp_lt_u32 s27, 2
    s_cselect_b32 s33, 38912, s30
    buffer_load_dwordx4 v13, s[4:7], s20 offen offset:3072 lds
    v_add_u32 v19, s33, v17
    s_cmp_eq_u32 s34, 0
    s_cselect_b32 s8, s42, s44
    s_cselect_b32 s9, s43, s45
    s_mov_b32 s10, 819200
    s_mov_b32 s11, 0x20000
    s_add_u32 m0, s76, 4096
    s_nop 0
    buffer_load_dwordx4 v17, s[8:11], s20 offen offset:0 lds
    buffer_load_dwordx4 v18, s[8:11], s20 offen offset:1024 lds
    buffer_load_dwordx4 v19, s[8:11], s20 offen offset:2048 lds
    v_and_b32 v3, 15, v0
    s_lshl_b32 s70, s28, 7
    s_lshl_b32 s32, s29, 3
    s_add_u32 s70, s70, s32
    s_and_b32 s32, s27, 1
    s_lshl_b32 s33, s32, 2
    s_add_u32 s70, s70, s33
    s_xor_b32 s32, s32, 1
    s_lshl_b32 s32, s32, 4
    s_add_u32 s71, s32, s28
    s_cmp_ge_u32 s71, 10
    s_cselect_b32 s33, 10, 0
    s_sub_u32 s32, s71, s33
    s_lshl_b32 s32, s32, 2
    s_mul_i32 s33, s29, 40
    s_add_u32 s32, s32, s33
    s_cmp_ge_u32 s27, 2
    s_cselect_b32 s70, s70, s32
    s_cselect_b32 s71, 0, s71
    v_add_u32_e64 v119, s70, v4
    v_mul_u32_u24 v7, 1280, v119
    v_lshl_add_u32 v118, v3, 4, v7
    v_bfrev_b32 v20, -2
    s_cmp_ge_u32 s71, 10
    s_cselect_b32 s78, s44, s42
    s_cselect_b32 s79, s45, s43
    s_cmp_ge_u32 s27, 2
    s_cselect_b32 s78, s36, s78
    s_cselect_b32 s79, s37, s79
    s_cmp_ge_u32 s71, 20
    s_cbranch_scc1 L_norow
    s_nop 0
    global_load_dwordx4 v[92:95], v118, s[78:79] offset:0
    global_load_dwordx4 v[96:99], v118, s[78:79] offset:256
    global_load_dwordx4 v[100:103], v118, s[78:79] offset:512
    global_load_dwordx4 v[104:107], v118, s[78:79] offset:768
    global_load_dwordx4 v[108:111], v118, s[78:79] offset:1024
L_norow:
    s_cmp_lg_u32 s27, 0
    s_cbranch_scc1 L_noparld
    s_mul_i32 s32, s29, 80
    v_min_u32_e64 v7, 39, v0
    v_lshl_add_u32 v7, v7, 1, s32
    global_load_ushort v124, v7, s[38:39]
    global_load_ushort v125, v7, s[40:41]
    global_load_ushort v126, v7, s[50:51]
L_noparld:
    s_lshl_b32 s66, s27, 8
    s_add_u32 s66, s66, s2
    s_cmp_ge_u32 s66, 400
    s_cselect_b32 s69, 400, 0
    s_sub_u32 s69, s66, s69
    s_mul_i32 s67, s69, 6554
    s_lshr_b32 s67, s67, 16
    s_mul_i32 s77, s67, 10
    s_sub_u32 s77, s69, s77
    s_cmp_ge_u32 s66, 880
    s_cbranch_scc1 L_norpld
    s_lshl_b32 s33, s27, 12
    s_add_u32 m0, s33, 86016
    s_mov_b32 s75, 0x20000
    v_mul_u32_u24 v7, 1280, v5
    s_cmp_ge_u32 s66, 400
    s_cbranch_scc1 L_w2ld
    v_xor_b32 v8, v4, v6
    v_lshl_add_u32 v9, v8, 4, v7
    v_xor_b32_e64 v8, 4, v8
    v_lshl_add_u32 v7, v8, 4, v7
    s_mul_i32 s32, s67, 20480
    s_lshl_b32 s33, s77, 7
    s_add_u32 s32, s32, s33
    s_add_u32 s33, s32, 9216
    s_mov_b32 s72, s46
    s_mov_b32 s73, s47
    s_mov_b32 s74, 819200
    buffer_load_dwordx4 v9, s[72:75], s32 offen lds
    buffer_load_dwordx4 v7, s[72:75], s33 offen offset:1024 lds
    s_mov_b32 s72, s48
    s_mov_b32 s73, s49
    s_add_u32 m0, m0, 2048
    s_nop 0
    buffer_load_dwordx4 v9, s[72:75], s32 offen lds
    buffer_load_dwordx4 v7, s[72:75], s33 offen offset:1024 lds
    s_branch L_rpld_done
L_w2ld:
    s_mov_b32 s72, s58
    s_mov_b32 s73, s59
    s_mov_b32 s74, 1966080
    v_lshlrev_b32 v8, 1, v4
    v_xor_b32 v8, v8, v6
    v_lshl_add_u32 v7, v8, 4, v7
    s_mul_i32 s32, s67, 40960
    s_lshl_b32 s33, s77, 7
    s_add_u32 s32, s32, s33
    buffer_load_dwordx4 v7, s[72:75], s32 offen offset:0 lds
    s_add_u32 s32, s32, 9216
    buffer_load_dwordx4 v7, s[72:75], s32 offen offset:1024 lds
    s_add_u32 s32, s32, 9216
    buffer_load_dwordx4 v7, s[72:75], s32 offen offset:2048 lds
    s_add_u32 s32, s32, 9216
    buffer_load_dwordx4 v7, s[72:75], s32 offen offset:3072 lds
    s_add_u32 s32, s32, 9216
    s_branch L_rpld_done
L_norpld:
    s_nop 0
    buffer_load_dword v21, v20, s[4:7], 0 offen
    buffer_load_dword v21, v20, s[4:7], 0 offen
    buffer_load_dword v21, v20, s[4:7], 0 offen
    buffer_load_dword v21, v20, s[4:7], 0 offen
L_rpld_done:
    s_add_u32 s20, s20, 128
    s_cmp_eq_u32 s20, 1280
    s_cselect_b32 s20, 0, s20
    s_add_u32 m0, s76, 28672
    s_nop 0
    buffer_load_dwordx4 v10, s[4:7], s20 offen offset:0 lds
    v_lshlrev_b32 v34, 4, v2
    s_mov_b32 s12, s64
    s_mov_b32 s13, s65
    s_nop 0
    s_mov_b32 s14, 268435456
    s_mov_b32 s15, 0x20000
    v_mov_b32 v30, 0x3f803f80
    v_mov_b32 v31, 0x3f803f80
    v_mov_b32 v32, 0x3f803f80
    v_mov_b32 v33, 0x3f803f80
    v_lshrrev_b32 v8, 1, v3
    v_lshlrev_b32 v7, 7, v3
    v_lshrrev_b32_e64 v9, 3, v3
    v_mul_u32_u24 v9, 6144, v9
    v_add_u32 v1, 0, v4
    v_xor_b32 v1, v1, v8
    v_lshl_add_u32 v1, v1, 4, v7
    v_add_u32_e64 v136, s76, v1
    v_add_u32 v1, 4096, v1
    v_add_u32_e64 v138, v1, v9
    v_add_u32 v140, 57344, v138
    v_add_u32 v1, 4, v4
    v_xor_b32 v1, v1, v8
    v_lshl_add_u32 v1, v1, 4, v7
    v_add_u32_e64 v137, s76, v1
    v_add_u32 v1, 4096, v1
    v_add_u32_e64 v139, v1, v9
    v_add_u32 v141, 57344, v139
    v_and_b32 v24, 3, v2
    v_lshlrev_b32 v24, 6, v24
    v_add_u32 v35, 4096, v34
    s_mul_i32 s32, s27, 49152
    s_mul_i32 s33, s29, 192
    s_add_u32 s32, s32, s33
    v_add_u32 v7, 0, v2
    buffer_load_dwordx4 v11, s[4:7], s20 offen offset:1024 lds
    v_mul_u32_u24 v8, 5462, v7
    v_lshrrev_b32_e64 v8, 16, v8
    v_mad_i32_i24 v7, v8, -12, v7
    v_lshrrev_b32 v1, 2, v8
    v_and_b32 v1, 2, v1
    v_xor_b32_e64 v7, v7, v1
    v_mul_u32_u24 v8, 3072, v8
    v_lshl_add_u32 v7, v7, 4, v8
    s_add_u32 s33, s32, 4096
    v_add_u32 v14, s33, v7
    v_add_u32 v7, 64, v2
    v_mul_u32_u24 v8, 5462, v7
    v_lshrrev_b32_e64 v8, 16, v8
    v_mad_i32_i24 v7, v8, -12, v7
    v_lshrrev_b32 v1, 2, v8
    v_and_b32 v1, 2, v1
    v_xor_b32_e64 v7, v7, v1
    v_mul_u32_u24 v8, 3072, v8
    v_lshl_add_u32 v7, v7, 4, v8
    s_add_u32 s33, s32, 3072
    v_add_u32_e64 v15, s33, v7
    v_add_u32 v7, 128, v2
    v_mul_u32_u24 v8, 5462, v7
    v_lshrrev_b32_e64 v8, 16, v8
    v_mad_i32_i24 v7, v8, -12, v7
    v_lshrrev_b32 v1, 2, v8
    v_and_b32 v1, 2, v1
    v_xor_b32_e64 v7, v7, v1
    v_mul_u32_u24 v8, 3072, v8
    v_lshl_add_u32 v7, v7, 4, v8
    s_add_u32 s33, s32, 2048
    v_add_u32_e64 v16, s33, v7
    s_sub_u32 s16, s56, 4096
    s_subb_u32 s17, s57, 0
    s_mov_b32 s18, 1970176
    buffer_load_dwordx4 v12, s[4:7], s20 offen offset:2048 lds
    s_mov_b32 s19, 0x20000
    s_mul_i32 s22, s27, 3072
    v_lshrrev_b32 v7, 1, v4
    v_mul_u32_u24 v7, 3072, v7
    v_and_b32 v8, 1, v4
    v_lshrrev_b32 v9, 2, v3
    v_lshl_add_u32 v9, v8, 3, v9
    v_mul_u32_u24 v9, 192, v9
    v_add_u32 v7, v7, v9
    v_and_b32 v9, 3, v3
    v_lshl_add_u32 v7, v9, 3, v7
    v_lshl_add_u32 v142, v8, 5, v7
    v_xor_b32_e64 v9, 1, v8
    v_lshl_add_u32 v143, v9, 5, v7
    v_add_u32 v144, 81920, v142
    v_add_u32 v145, 81920, v143
    s_lshl_b32 s32, s27, 6
    s_sub_u32 s32, s32, 64
    v_add_u32 v146, s32, v142
    v_add_u32 v147, s32, v143
    v_add_u32 v148, s32, v144
    v_add_u32 v149, s32, v145
    s_and_b32 s32, s29, 7
    s_mul_i32 s32, s32, 88
    s_lshr_b32 s33, s29, 3
    s_lshl_b32 s33, s33, 2
    s_add_u32 s33, s33, s27
    s_mul_i32 s34, s33, 5
    s_add_u32 s34, s34, s32
    s_mul_i32 s34, s34, 5120
    s_add_u32 s70, s34, 16777216
    s_mul_i32 s34, s33, 6
    s_add_u32 s34, s34, s32
    s_mul_i32 s34, s34, 5120
    buffer_load_dwordx4 v13, s[4:7], s20 offen offset:3072 lds
    s_add_u32 s69, s34, 16982016
    v_lshlrev_b32_e64 v22, 4, v3
    v_add_u32 v22, 147456, v22
    s_lshl_b32 s32, s29, 4
    s_lshl_b32 s33, s27, 2
    s_add_u32 s32, s32, s33
    v_mov_b32 v6, s32
    v_lshlrev_b32 v120, 5, v4
    v_lshrrev_b32 v8, 2, v3
    v_and_b32_e64 v9, 3, v3
    v_lshl_add_u32 v8, v8, 3, v9
    v_lshlrev_b32 v121, 2, v8
    v_lshlrev_b32 v122, 2, v3
    s_lshr_b32 s3, s29, 3
    s_lshl_b32 s3, s3, 6
    s_lshr_b32 s33, s27, 1
    s_lshl_b32 s33, s33, 5
    s_add_u32 s3, s3, s33
    s_and_b32 s33, s27, 1
    s_lshl_b32 s33, s33, 2
    s_add_u32 s3, s3, s33
    s_lshl_b32 s33, s28, 7
    s_add_u32 s3, s3, s33
    v_lshrrev_b32 v5, 2, v3
    v_and_b32 v1, 3, v3
    v_lshl_add_u32 v5, v5, 3, v1
    v_add_u32 v5, s3, v5
    v_lshlrev_b32 v123, 2, v5
    v_mul_u32_u24 v5, 640, v5
    s_and_b32 s24, s29, 7
    s_mul_i32 s24, s24, 80
    v_lshl_add_u32 v7, v4, 2, s24
    v_add_u32 v5, v5, v7
    v_lshlrev_b32_e64 v5, 2, v5
    s_add_u32 m0, s76, 32768
    s_nop 0
    buffer_load_dwordx4 v17, s[8:11], s20 offen offset:0 lds
    s_lshl_b32 s24, s24, 1
    s_mul_i32 s3, s3, 1280
    s_add_u32 s25, s3, s24
    v_add_u32 v7, 0, v2
    v_mul_u32_u24 v8, 6554, v7
    v_lshrrev_b32_e64 v8, 16, v8
    v_mad_i32_i24 v7, v8, -10, v7
    v_lshrrev_b32 v9, 2, v8
    v_and_b32 v8, 3, v8
    v_lshl_add_u32 v8, v9, 3, v8
    v_mul_u32_u24 v8, 1280, v8
    v_lshl_add_u32 v248, v7, 4, v8
    v_add_u32_e64 v7, 64, v2
    v_mul_u32_u24 v8, 6554, v7
    v_lshrrev_b32_e64 v8, 16, v8
    v_mad_i32_i24 v7, v8, -10, v7
    v_lshrrev_b32 v9, 2, v8
    v_and_b32 v8, 3, v8
    v_lshl_add_u32 v8, v9, 3, v8
    v_mul_u32_u24 v8, 1280, v8
    v_lshl_add_u32 v249, v7, 4, v8
    v_add_u32 v7, 128, v2
    v_mul_u32_u24 v8, 6554, v7
    v_lshrrev_b32_e64 v8, 16, v8
    v_mad_i32_i24 v7, v8, -10, v7
    v_lshrrev_b32 v9, 2, v8
    v_and_b32 v8, 3, v8
    v_lshl_add_u32 v8, v9, 3, v8
    v_mul_u32_u24 v8, 1280, v8
    v_lshl_add_u32 v250, v7, 4, v8
    v_add_u32 v249, 4294966272, v249
    v_add_u32 v250, 4294965248, v250
    s_mul_i32 s26, s27, 3072
    s_add_u32 s26, s26, 110592
    buffer_load_dwordx4 v18, s[8:11], s20 offen offset:1024 lds
    v_mul_u32_u24 v254, 160, v3
    v_lshl_add_u32 v254, v4, 3, v254
    v_add_u32 v254, s26, v254
    v_lshlrev_b32 v255, 3, v4
    v_add_u32_e64 v255, s26, v255
    s_mul_i32 s32, s27, 5120
    s_add_u32 s32, s32, 86016
    v_lshrrev_b32 v243, 2, v3
    v_and_b32 v7, 1, v243
    v_xor_b32 v7, v7, v4
    v_lshlrev_b32 v7, 2, v7
    v_lshl_add_u32 v7, v243, 4, v7
    v_and_b32 v8, 3, v3
    v_add_u32 v7, v7, v8
    v_lshl_add_u32 v240, v7, 4, s32
    v_lshrrev_b32 v7, 1, v4
    v_lshlrev_b32 v9, 9, v7
    v_lshl_add_u32 v9, v243, 4, v9
    v_and_b32_e64 v243, 1, v4
    v_lshl_add_u32 v9, v243, 3, v9
    v_add_u32_e64 v9, s32, v9
    v_lshl_add_u32 v241, v8, 6, v9
    v_xor_b32_e64 v8, 1, v8
    v_lshl_add_u32 v242, v8, 6, v9
    v_lshlrev_b32_e64 v243, 10, v243
    v_lshl_add_u32 v243, v7, 8, v243
    v_lshl_add_u32 v243, v3, 4, v243
    s_lshl_b32 s32, s28, 1
    s_lshr_b32 s33, s27, 1
    s_add_u32 s32, s32, s33
    s_mul_i32 s32, s32, 360448
    s_and_b32 s33, s27, 1
    s_lshl_b32 s33, s33, 11
    s_add_u32 s74, s32, s33
    buffer_load_dwordx4 v19, s[8:11], s20 offen offset:2048 lds
    s_add_u32 s74, s74, 4194304
    s_mul_i32 s33, s29, 5
    s_and_b32 s34, s33, 1
    s_lshr_b32 s32, s33, 1
    s_lshl_b32 s32, s32, 12
    s_add_u32 s30, s32, s74
    s_mul_i32 s31, s34, 3072
    s_add_u32 s31, s31, 512
    s_lshl_b32 s34, s34, 9
    s_add_u32 s30, s30, s34
    v_min_u32 v7, 39, v2
    v_lshrrev_b32_e64 v8, 3, v7
    v_lshl_add_u32 v8, v8, 3, v7
    v_lshlrev_b32_e64 v8, 2, v8
    v_add_u32 v244, 149248, v8
    v_add_u32 v245, 150528, v8
    v_add_u32 v246, 151808, v8
    v_add_u32 v247, 153088, v8
    s_sub_u32 s32, 15, s28
    s_mul_i32 s32, s32, 320
    v_lshl_add_u32 v236, v7, 3, s32
    v_add_u32 v237, 320, v236
    v_add_u32 v238, 4480, v236
    s_lshl_b32 s32, s27, 2
    v_add_u32_e64 v239, s32, v4
    v_mul_u32_u24 v239, 320, v239
    v_lshl_add_u32 v239, v3, 2, v239
    v_add_u32 v239, 149248, v239
    s_waitcnt vmcnt(11)
    s_barrier
    ds_read_b128 a[0:3], v136 offset:0
    ds_read_b128 a[4:7], v136 offset:2048
    ds_read_b128 a[160:163], v138 offset:0
    ds_read_b128 a[164:167], v138 offset:14336
    ds_read_b128 a[168:171], v138 offset:1024
    ds_read_b128 a[172:175], v138 offset:15360
    ds_read_b128 a[176:179], v138 offset:2048
    s_waitcnt lgkmcnt(0)
    v_mfma_f32_16x16x32_bf16 v[36:39], a[0:3], a[160:163], 0
    ds_read_b128 a[8:11], v137 offset:0
    s_add_u32 s20, s20, 128
    s_cmp_eq_u32 s20, 1280
    s_cselect_b32 s20, 0, s20
    s_add_u32 m0, s76, 57344
    s_nop 0
    v_mfma_f32_16x16x32_bf16 v[40:43], a[4:7], a[160:163], 0
    ds_read_b128 a[12:15], v137 offset:2048
    buffer_load_dwordx4 v10, s[4:7], s20 offen offset:0 lds
    v_mfma_f32_16x16x32_bf16 v[44:47], a[0:3], a[164:167], 0
    ds_read_b128 a[180:183], v139 offset:0
    buffer_load_dwordx4 v11, s[4:7], s20 offen offset:1024 lds
    v_mfma_f32_16x16x32_bf16 v[48:51], a[4:7], a[164:167], 0
    ds_read_b128 a[184:187], v139 offset:14336
    buffer_load_dwordx4 v12, s[4:7], s20 offen offset:2048 lds
    v_mfma_f32_16x16x32_bf16 v[52:55], a[0:3], a[168:171], 0
    ds_read_b128 a[188:191], v139 offset:1024
    buffer_load_dwordx4 v13, s[4:7], s20 offen offset:3072 lds
    v_mfma_f32_16x16x32_bf16 v[56:59], a[4:7], a[168:171], 0
    ds_read_b128 a[192:195], v139 offset:15360
    s_add_u32 m0, s76, 61440
    s_nop 0
    v_mfma_f32_16x16x32_bf16 v[60:63], a[0:3], a[172:175], 0
    ds_read_b128 a[196:199], v139 offset:2048
    buffer_load_dwordx4 v17, s[8:11], s20 offen offset:0 lds
    v_mfma_f32_16x16x32_bf16 v[64:67], a[4:7], a[172:175], 0
    buffer_load_dwordx4 v18, s[8:11], s20 offen offset:1024 lds
    v_mfma_f32_16x16x32_bf16 v[68:71], a[0:3], a[176:179], 0
    buffer_load_dwordx4 v19, s[8:11], s20 offen offset:2048 lds
    v_mfma_f32_16x16x32_bf16 v[72:75], a[4:7], a[176:179], 0
    s_cmp_ge_u32 s71, 20
    s_cbranch_scc1 L_norowst
    v_dot2_f32_bf16 v112, v92, v30, 0
    v_dot2_f32_bf16 v114, v92, v92, 0
    v_dot2_f32_bf16 v113, v93, v30, 0
    v_dot2_f32_bf16 v115, v93, v93, 0
    v_dot2_f32_bf16 v112, v94, v30, v112
    v_dot2_f32_bf16 v114, v94, v94, v114
    v_dot2_f32_bf16 v113, v95, v30, v113
    v_dot2_f32_bf16 v115, v95, v95, v115
    v_dot2_f32_bf16 v112, v96, v30, v112
    v_dot2_f32_bf16 v114, v96, v96, v114
    v_dot2_f32_bf16 v113, v97, v30, v113
    v_dot2_f32_bf16 v115, v97, v97, v115
    v_dot2_f32_bf16 v112, v98, v30, v112
    v_dot2_f32_bf16 v114, v98, v98, v114
    v_dot2_f32_bf16 v113, v99, v30, v113
    v_dot2_f32_bf16 v115, v99, v99, v115
    v_dot2_f32_bf16 v112, v100, v30, v112
    v_dot2_f32_bf16 v114, v100, v100, v114
    v_dot2_f32_bf16 v113, v101, v30, v113
    v_dot2_f32_bf16 v115, v101, v101, v115
    v_dot2_f32_bf16 v112, v102, v30, v112
    v_dot2_f32_bf16 v114, v102, v102, v114
    v_dot2_f32_bf16 v113, v103, v30, v113
    v_dot2_f32_bf16 v115, v103, v103, v115
    v_dot2_f32_bf16 v112, v104, v30, v112
    v_dot2_f32_bf16 v114, v104, v104, v114
    v_dot2_f32_bf16 v113, v105, v30, v113
    v_dot2_f32_bf16 v115, v105, v105, v115
    v_dot2_f32_bf16 v112, v106, v30, v112
    v_dot2_f32_bf16 v114, v106, v106, v114
    v_dot2_f32_bf16 v113, v107, v30, v113
    v_dot2_f32_bf16 v115, v107, v107, v115
    v_dot2_f32_bf16 v112, v108, v30, v112
    v_dot2_f32_bf16 v114, v108, v108, v114
    v_dot2_f32_bf16 v113, v109, v30, v113
    v_dot2_f32_bf16 v115, v109, v109, v115
    v_dot2_f32_bf16 v112, v110, v30, v112
    v_dot2_f32_bf16 v114, v110, v110, v114
    v_dot2_f32_bf16 v113, v111, v30, v113
    v_dot2_f32_bf16 v115, v111, v111, v115
    s_mov_b32 s32, 0x3acccccd
    s_nop 1
    v_add_f32 v112, v112, v113
    v_add_f32 v114, v114, v115
    s_nop 0
    v_add_f32_dpp v112, v112, v112 row_ror:8 row_mask:0xf bank_mask:0xf
    v_add_f32_dpp v114, v114, v114 row_ror:8 row_mask:0xf bank_mask:0xf
    s_nop 0
    v_add_f32_dpp v112, v112, v112 row_ror:4 row_mask:0xf bank_mask:0xf
    v_add_f32_dpp v114, v114, v114 row_ror:4 row_mask:0xf bank_mask:0xf
    s_nop 0
    v_add_f32_dpp v112, v112, v112 row_ror:2 row_mask:0xf bank_mask:0xf
    v_add_f32_dpp v114, v114, v114 row_ror:2 row_mask:0xf bank_mask:0xf
    s_nop 0
    v_add_f32_dpp v112, v112, v112 row_ror:1 row_mask:0xf bank_mask:0xf
    v_add_f32_dpp v114, v114, v114 row_ror:1 row_mask:0xf bank_mask:0xf
    s_nop 0
    s_mov_b32 exec_lo, 0x10001
    s_mov_b32 exec_hi, 0x10001
    s_cmp_lt_u32 s27, 2
    s_cbranch_scc1 L_bsum
    v_mul_f32 v112, s32, v112
    v_mul_f32 v114, s32, v114
    v_fma_f32 v114, -v112, v112, v114
    v_max_f32_e64 v114, 0, v114
    v_cvt_pk_bf16_f32 v7, v112, v114
    v_lshlrev_b32_e64 v112, 16, v7
    v_and_b32 v7, 0xffff0000, v7
    v_add_f32 v7, 0x3727c5ac, v7
    v_cvt_pk_bf16_f32 v7, v7, v7
    v_lshlrev_b32 v7, 16, v7
    v_sqrt_f32 v7, v7
    v_lshlrev_b32_e64 v8, 2, v119
    v_cvt_pk_bf16_f32 v7, v7, v7
    v_lshlrev_b32 v7, 16, v7
    v_rcp_f32 v7, v7
    s_mov_b32 s32, 21118976
    s_mov_b32 s33, 21127168
    buffer_store_dword v112, v8, s[12:15], s32 offen sc1
    buffer_store_dword v7, v8, s[12:15], s33 offen sc1
    s_branch L_rowst_done
L_bsum:
    v_and_b32 v7, -8, v119
    v_add_u32 v7, v7, v119
    v_lshlrev_b32 v7, 2, v7
    s_cmp_lt_u32 s71, 10
    s_cselect_b32 s32, 0, 32
    s_add_u32 s32, s32, 21135360
    buffer_store_dword v112, v7, s[12:15], s32 offen sc1
    buffer_load_dword v21, v20, s[4:7], 0 offen
L_rowst_done:
    s_mov_b64 exec, -1
    s_branch L_rowst_end
L_norowst:
    buffer_load_dword v21, v20, s[4:7], 0 offen
    buffer_load_dword v21, v20, s[4:7], 0 offen
L_rowst_end:
    s_lshl_b32 s68, s28, 8
    s_add_u32 s68, s68, 21102592
    s_cmp_lg_u32 s27, 1
    s_cbranch_scc1 L_noreset
    v_mov_b32 v8, -1
    v_mov_b32 v9, -1
    v_min_u32 v7, 39, v2
    v_lshlrev_b32 v7, 3, v7
    s_mul_i32 s32, s29, 16
    s_sub_u32 s32, s32, s28
    s_add_u32 s32, s32, 15
    s_mul_i32 s32, s32, 320
    s_add_u32 s32, s32, 20971520
    buffer_store_dwordx2 v[8:9], v7, s[12:15], s32 offen sc1
    v_lshrrev_b32 v7, 2, v2
    v_lshlrev_b32 v7, 12, v7
    v_and_b32_e64 v8, 3, v2
    v_lshl_add_u32 v7, v8, 2, v7
    v_mov_b32 v1, 0
    s_lshl_b32 s33, s29, 4
    s_add_u32 s32, s68, s33
    s_mov_b64 exec, 0xfff
    buffer_store_dword v1, v7, s[12:15], s32 offen sc1
    s_mov_b64 exec, -1
    s_branch L_reset_end
L_noreset:
    buffer_load_dword v21, v20, s[4:7], 0 offen
    buffer_load_dword v21, v20, s[4:7], 0 offen
L_reset_end:
    s_cmp_lg_u32 s27, 0
    s_cbranch_scc1 L_nopar
    v_lshlrev_b32 v124, 16, v124
    v_lshlrev_b32 v125, 16, v125
    v_lshlrev_b32 v126, 16, v126
    v_mul_f32 v126, 0x3fb8aa3b, v126
    v_exp_f32 v126, v126
    v_min_u32 v7, 39, v0
    v_cvt_pk_bf16_f32 v126, v126, v126
    v_lshlrev_b32 v126, 16, v126
    v_mul_f32 v127, v126, v124
    v_mul_f32_e64 v128, v126, v125
    v_mul_f32 v127, 0x3fb8aa3b, v127
    v_exp_f32 v127, v127
    v_mul_f32 v128, 0.15915494, v128
    v_fract_f32 v128, v128
    v_cos_f32 v129, v128
    v_sin_f32 v130, v128
    v_and_b32 v8, -8, v7
    v_mul_f32 v132, v127, v129
    v_mul_f32 v133, v127, v130
    v_add_f32 v128, -1.0, v132
    v_mul_f32 v129, v124, v124
    v_fmac_f32 v129, v125, v125
    v_rcp_f32 v129, v129
    v_mul_f32 v134, v128, v124
    v_fmac_f32 v134, v133, v125
    v_mul_f32_e64 v135, v128, v125
    v_fma_f32 v135, -v133, v124, v135
    v_add_f32 v129, v129, v129
    v_mul_f32 v134, v134, v129
    v_mul_f32_e64 v135, v135, v129
    v_add_lshl_u32 v7, v7, v8, 4
    v_add_u32 v7, 147456, v7
    v_mov_b32_e64 v124, v132
    v_xor_b32 v125, 0x80000000, v133
    v_mov_b32 v126, v134
    v_mov_b32 v127, v135
    v_xor_b32 v134, 0x80000000, v134
    ds_write_b128 v7, v[124:127]
    ds_write_b128 v7, v[132:135] offset:128
    v_pk_mul_f32 v[128:129], v[132:133], v[132:133] op_sel:[1,1] op_sel_hi:[1,0]
    v_pk_fma_f32 v[124:125], v[132:133], v[132:133], v[128:129] op_sel_hi:[0,1,1] neg_lo:[0,0,1]
    v_pk_mul_f32 v[128:129], v[124:125], v[124:125] op_sel:[1,1] op_sel_hi:[1,0]
    v_pk_fma_f32 v[126:127], v[124:125], v[124:125], v[128:129] op_sel_hi:[0,1,1] neg_lo:[0,0,1]
    v_pk_mul_f32 v[128:129], v[126:127], v[126:127] op_sel:[1,1] op_sel_hi:[1,0]
    v_pk_fma_f32 v[26:27], v[126:127], v[126:127], v[128:129] op_sel_hi:[0,1,1] neg_lo:[0,0,1]
    v_pk_mul_f32 v[128:129], v[26:27], v[26:27] op_sel:[1,1] op_sel_hi:[1,0]
    v_pk_fma_f32 v[126:127], v[26:27], v[26:27], v[128:129] op_sel_hi:[0,1,1] neg_lo:[0,0,1]
    v_pk_mul_f32 v[128:129], v[126:127], v[126:127] op_sel:[1,1] op_sel_hi:[1,0]
    v_pk_fma_f32 v[124:125], v[126:127], v[126:127], v[128:129] op_sel_hi:[0,1,1] neg_lo:[0,0,1]
    v_pk_mul_f32 v[128:129], v[124:125], v[124:125] op_sel:[1,1] op_sel_hi:[1,0]
    v_pk_fma_f32 v[126:127], v[124:125], v[124:125], v[128:129] op_sel_hi:[0,1,1] neg_lo:[0,0,1]
    v_pk_mul_f32 v[128:129], v[126:127], v[126:127] op_sel:[1,1] op_sel_hi:[1,0]
    v_pk_fma_f32 v[28:29], v[126:127], v[126:127], v[128:129] op_sel_hi:[0,1,1] neg_lo:[0,0,1]
L_nopar:
    s_waitcnt vmcnt(11) lgkmcnt(0)
    s_barrier
    v_mfma_f32_16x16x32_bf16 v[36:39], a[8:11], a[180:183], v[36:39]
    ds_read_b128 a[16:19], v136 offset:28672
    s_add_u32 s20, s20, 128
    s_cmp_eq_u32 s20, 1280
    s_cselect_b32 s20, 0, s20
    s_add_u32 m0, s76, 0
    s_nop 0
    v_mfma_f32_16x16x32_bf16 v[40:43], a[12:15], a[180:183], v[40:43]
    ds_read_b128 a[20:23], v136 offset:30720
    buffer_load_dwordx4 v10, s[4:7], s20 offen offset:0 lds
    v_mfma_f32_16x16x32_bf16 v[44:47], a[8:11], a[184:187], v[44:47]
    ds_read_b128 a[160:163], v138 offset:28672
    v_mfma_f32_16x16x32_bf16 v[48:51], a[12:15], a[184:187], v[48:51]
    ds_read_b128 a[164:167], v138 offset:43008
    buffer_load_dwordx4 v11, s[4:7], s20 offen offset:1024 lds
    v_mfma_f32_16x16x32_bf16 v[52:55], a[8:11], a[188:191], v[52:55]
    ds_read_b128 a[168:171], v138 offset:29696
    v_mfma_f32_16x16x32_bf16 v[56:59], a[12:15], a[188:191], v[56:59]
    ds_read_b128 a[172:175], v138 offset:44032
    buffer_load_dwordx4 v12, s[4:7], s20 offen offset:2048 lds
    v_mfma_f32_16x16x32_bf16 v[60:63], a[8:11], a[192:195], v[60:63]
    ds_read_b128 a[176:179], v138 offset:30720
    v_mfma_f32_16x16x32_bf16 v[64:67], a[12:15], a[192:195], v[64:67]
    buffer_load_dwordx4 v13, s[4:7], s20 offen offset:3072 lds
    v_mfma_f32_16x16x32_bf16 v[68:71], a[8:11], a[196:199], v[68:71]
    v_mfma_f32_16x16x32_bf16 v[72:75], a[12:15], a[196:199], v[72:75]
    s_waitcnt vmcnt(22)
    s_cmp_ge_u32 s66, 400
    s_cbranch_scc1 L_w2st
    s_mul_i32 s77, s77, 20
    v_and_b32 v7, 1, v4
    v_lshlrev_b32 v7, 11, v7
    v_lshl_add_u32 v7, v3, 7, v7
    v_lshrrev_b32 v8, 1, v4
    v_lshrrev_b32 v9, 1, v3
    v_xor_b32_e64 v8, v8, v9
    v_lshl_add_u32 v8, v8, 4, v7
    s_lshl_b32 s33, s27, 12
    s_add_u32 s33, s33, 86016
    v_add_u32 v8, s33, v8
    v_xor_b32_e64 v7, 0, v8
    ds_read_b128 v[76:79], v7
    v_xor_b32_e64 v7, 32, v8
    ds_read_b128 v[80:83], v7
    v_xor_b32_e64 v7, 64, v8
    ds_read_b128 v[84:87], v7
    v_xor_b32 v7, 96, v8
    ds_read_b128 v[88:91], v7
    s_mul_i32 s32, s67, 13108
    s_lshr_b32 s32, s32, 16
    s_mul_i32 s32, s32, 435
    s_add_u32 s32, s32, s67
    s_add_u32 s32, s32, s77
    s_lshl_b32 s32, s32, 10
    s_add_u32 s32, s32, 16777216
    s_waitcnt lgkmcnt(0)
    s_nop 0
    buffer_store_dwordx4 v[76:79], v34, s[12:15], s32 offen sc1
    s_add_u32 s32, s32, 5120
    buffer_store_dwordx4 v[80:83], v34, s[12:15], s32 offen sc1
    s_add_u32 s32, s32, 5120
    buffer_store_dwordx4 v[84:87], v34, s[12:15], s32 offen sc1
    s_add_u32 s32, s32, 5120
    buffer_store_dwordx4 v[88:91], v34, s[12:15], s32 offen sc1
    s_add_u32 s32, s32, 5120
    s_branch L_rpst_done
L_norpst:
    buffer_load_dword v21, v20, s[4:7], 0 offen
    buffer_load_dword v21, v20, s[4:7], 0 offen
    buffer_load_dword v21, v20, s[4:7], 0 offen
    buffer_load_dword v21, v20, s[4:7], 0 offen
    s_branch L_rpst_done
L_w2st:
    s_cmp_ge_u32 s66, 880
    s_cbranch_scc1 L_norpst
    v_lshrrev_b32 v7, 2, v3
    v_lshl_add_u32 v7, v4, 2, v7
    v_lshlrev_b32_e64 v8, 7, v7
    v_bfe_u32 v7, v7, 1, 2
    v_lshl_add_u32 v8, v7, 5, v8
    v_and_b32_e64 v7, 3, v3
    v_lshl_add_u32 v8, v7, 3, v8
    s_lshl_b32 s33, s27, 12
    s_add_u32 s33, s33, 86016
    v_add_u32 v8, s33, v8
    v_xor_b32_e64 v7, 0, v8
    ds_read_b64_tr_b16 v[76:77], v7
    ds_read_b64_tr_b16 v[78:79], v7 offset:2048
    v_xor_b32_e64 v7, 32, v8
    ds_read_b64_tr_b16 v[80:81], v7
    ds_read_b64_tr_b16 v[82:83], v7 offset:2048
    v_xor_b32_e64 v7, 64, v8
    ds_read_b64_tr_b16 v[84:85], v7
    ds_read_b64_tr_b16 v[86:87], v7 offset:2048
    v_xor_b32 v7, 96, v8
    ds_read_b64_tr_b16 v[88:89], v7
    ds_read_b64_tr_b16 v[90:91], v7 offset:2048
    s_mul_i32 s67, s67, 5
    s_add_u32 s67, s67, 16584
    s_lshl_b32 s77, s77, 2
    s_mul_i32 s32, s77, 13108
    s_lshr_b32 s32, s32, 16
    s_mul_i32 s32, s32, 435
    s_add_u32 s32, s32, s77
    s_add_u32 s32, s32, s67
    s_lshl_b32 s32, s32, 10
    s_waitcnt lgkmcnt(6)
    buffer_store_dwordx4 v[76:79], v34, s[12:15], s32 offen sc1
    s_add_u32 s77, s77, 1
    s_mul_i32 s32, s77, 13108
    s_lshr_b32 s32, s32, 16
    s_mul_i32 s32, s32, 435
    s_add_u32 s32, s32, s77
    s_add_u32 s32, s32, s67
    s_lshl_b32 s32, s32, 10
    s_waitcnt lgkmcnt(4)
    buffer_store_dwordx4 v[80:83], v34, s[12:15], s32 offen sc1
    s_add_u32 s77, s77, 1
    s_mul_i32 s32, s77, 13108
    s_lshr_b32 s32, s32, 16
    s_mul_i32 s32, s32, 435
    s_add_u32 s32, s32, s77
    s_add_u32 s32, s32, s67
    s_lshl_b32 s32, s32, 10
    s_waitcnt lgkmcnt(2)
    buffer_store_dwordx4 v[84:87], v34, s[12:15], s32 offen sc1
    s_add_u32 s77, s77, 1
    s_mul_i32 s32, s77, 13108
    s_lshr_b32 s32, s32, 16
    s_mul_i32 s32, s32, 435
    s_add_u32 s32, s32, s77
    s_add_u32 s32, s32, s67
    s_lshl_b32 s32, s32, 10
    s_waitcnt lgkmcnt(0)
    buffer_store_dwordx4 v[88:91], v34, s[12:15], s32 offen sc1
    s_add_u32 s77, s77, 1
L_rpst_done:
    s_waitcnt lgkmcnt(0)
    v_mfma_f32_16x16x32_bf16 v[36:39], a[16:19], a[160:163], v[36:39]
    ds_read_b128 a[24:27], v137 offset:28672
    s_add_u32 m0, s76, 4096
    s_nop 0
    v_mfma_f32_16x16x32_bf16 v[40:43], a[20:23], a[160:163], v[40:43]
    ds_read_b128 a[28:31], v137 offset:30720
    buffer_load_dwordx4 v17, s[8:11], s20 offen offset:0 lds
    v_mfma_f32_16x16x32_bf16 v[44:47], a[16:19], a[164:167], v[44:47]
    ds_read_b128 a[180:183], v139 offset:28672
    v_mfma_f32_16x16x32_bf16 v[48:51], a[20:23], a[164:167], v[48:51]
    ds_read_b128 a[184:187], v139 offset:43008
    v_mfma_f32_16x16x32_bf16 v[52:55], a[16:19], a[168:171], v[52:55]
    ds_read_b128 a[188:191], v139 offset:29696
    buffer_load_dwordx4 v18, s[8:11], s20 offen offset:1024 lds
    v_mfma_f32_16x16x32_bf16 v[56:59], a[20:23], a[168:171], v[56:59]
    ds_read_b128 a[192:195], v139 offset:44032
    v_mfma_f32_16x16x32_bf16 v[60:63], a[16:19], a[172:175], v[60:63]
    ds_read_b128 a[196:199], v139 offset:30720
    v_mfma_f32_16x16x32_bf16 v[64:67], a[20:23], a[172:175], v[64:67]
    buffer_load_dwordx4 v19, s[8:11], s20 offen offset:2048 lds
    v_mfma_f32_16x16x32_bf16 v[68:71], a[16:19], a[176:179], v[68:71]
    v_mfma_f32_16x16x32_bf16 v[72:75], a[20:23], a[176:179], v[72:75]
    s_waitcnt vmcnt(15) lgkmcnt(0)
    s_barrier
    v_mfma_f32_16x16x32_bf16 v[36:39], a[24:27], a[180:183], v[36:39]
    ds_read_b128 a[32:35], v136 offset:57344
    s_add_u32 s20, s20, 128
    s_cmp_eq_u32 s20, 1280
    s_cselect_b32 s20, 0, s20
    s_add_u32 m0, s76, 28672
    s_nop 0
    v_mfma_f32_16x16x32_bf16 v[40:43], a[28:31], a[180:183], v[40:43]
    ds_read_b128 a[36:39], v136 offset:59392
    buffer_load_dwordx4 v10, s[4:7], s20 offen offset:0 lds
    v_mfma_f32_16x16x32_bf16 v[44:47], a[24:27], a[184:187], v[44:47]
    ds_read_b128 a[160:163], v140 offset:0
    v_mfma_f32_16x16x32_bf16 v[48:51], a[28:31], a[184:187], v[48:51]
    ds_read_b128 a[164:167], v140 offset:14336
    buffer_load_dwordx4 v11, s[4:7], s20 offen offset:1024 lds
    v_mfma_f32_16x16x32_bf16 v[52:55], a[24:27], a[188:191], v[52:55]
    ds_read_b128 a[168:171], v140 offset:1024
    v_mfma_f32_16x16x32_bf16 v[56:59], a[28:31], a[188:191], v[56:59]
    ds_read_b128 a[172:175], v140 offset:15360
    buffer_load_dwordx4 v12, s[4:7], s20 offen offset:2048 lds
    v_mfma_f32_16x16x32_bf16 v[60:63], a[24:27], a[192:195], v[60:63]
    ds_read_b128 a[176:179], v140 offset:2048
    v_mfma_f32_16x16x32_bf16 v[64:67], a[28:31], a[192:195], v[64:67]
    buffer_load_dwordx4 v13, s[4:7], s20 offen offset:3072 lds
    v_mfma_f32_16x16x32_bf16 v[68:71], a[24:27], a[196:199], v[68:71]
    v_mfma_f32_16x16x32_bf16 v[72:75], a[28:31], a[196:199], v[72:75]
    s_waitcnt lgkmcnt(0)
    v_mfma_f32_16x16x32_bf16 v[36:39], a[32:35], a[160:163], v[36:39]
    ds_read_b128 a[40:43], v137 offset:57344
    s_add_u32 m0, s76, 32768
    s_nop 0
    v_mfma_f32_16x16x32_bf16 v[40:43], a[36:39], a[160:163], v[40:43]
    ds_read_b128 a[44:47], v137 offset:59392
    buffer_load_dwordx4 v17, s[8:11], s20 offen offset:0 lds
    v_mfma_f32_16x16x32_bf16 v[44:47], a[32:35], a[164:167], v[44:47]
    ds_read_b128 a[180:183], v141 offset:0
    v_mfma_f32_16x16x32_bf16 v[48:51], a[36:39], a[164:167], v[48:51]
    ds_read_b128 a[184:187], v141 offset:14336
    v_mfma_f32_16x16x32_bf16 v[52:55], a[32:35], a[168:171], v[52:55]
    ds_read_b128 a[188:191], v141 offset:1024
    buffer_load_dwordx4 v18, s[8:11], s20 offen offset:1024 lds
    v_mfma_f32_16x16x32_bf16 v[56:59], a[36:39], a[168:171], v[56:59]
    ds_read_b128 a[192:195], v141 offset:15360
    v_mfma_f32_16x16x32_bf16 v[60:63], a[32:35], a[172:175], v[60:63]
    ds_read_b128 a[196:199], v141 offset:2048
    v_mfma_f32_16x16x32_bf16 v[64:67], a[36:39], a[172:175], v[64:67]
    buffer_load_dwordx4 v19, s[8:11], s20 offen offset:2048 lds
    v_mfma_f32_16x16x32_bf16 v[68:71], a[32:35], a[176:179], v[68:71]
    v_mfma_f32_16x16x32_bf16 v[72:75], a[36:39], a[176:179], v[72:75]
    s_waitcnt vmcnt(7) lgkmcnt(0)
    s_barrier
    s_cmp_lg_u32 s27, 3
    s_cbranch_scc1 L_noarr
    s_and_b32 s3, s2, 3
    s_lshl_b32 s3, s3, 6
    v_mov_b32 v8, s3
    v_mov_b32 v9, 1
    s_mov_b64 exec, 1
    global_atomic_add v8, v9, s[62:63] sc1
    s_mov_b64 exec, -1
    s_branch L_arr_end
L_noarr:
    buffer_load_dword v21, v20, s[4:7], 0 offen
L_arr_end:
    v_mfma_f32_16x16x32_bf16 v[36:39], a[40:43], a[180:183], v[36:39]
    ds_read_b128 a[48:51], v136 offset:0
    s_add_u32 s20, s20, 128
    s_cmp_eq_u32 s20, 1280
    s_cselect_b32 s20, 0, s20
    s_add_u32 m0, s76, 57344
    s_nop 0
    ds_read_b128 v[180:183], v22 offset:0
    v_mfma_f32_16x16x32_bf16 v[40:43], a[44:47], a[180:183], v[40:43]
    ds_read_b128 a[52:55], v136 offset:2048
    buffer_load_dwordx4 v10, s[4:7], s20 offen offset:0 lds
    v_mfma_f32_16x16x32_bf16 v[44:47], a[40:43], a[184:187], v[44:47]
    ds_read_b128 a[160:163], v138 offset:0
    ds_read_b128 v[184:187], v22 offset:256
    v_mfma_f32_16x16x32_bf16 v[48:51], a[44:47], a[184:187], v[48:51]
    ds_read_b128 a[164:167], v138 offset:14336
    buffer_load_dwordx4 v11, s[4:7], s20 offen offset:1024 lds
    v_mfma_f32_16x16x32_bf16 v[52:55], a[40:43], a[188:191], v[52:55]
    ds_read_b128 a[168:171], v138 offset:1024
    ds_read_b128 v[188:191], v22 offset:512
    v_mfma_f32_16x16x32_bf16 v[56:59], a[44:47], a[188:191], v[56:59]
    ds_read_b128 a[172:175], v138 offset:15360
    buffer_load_dwordx4 v12, s[4:7], s20 offen offset:2048 lds
    v_mfma_f32_16x16x32_bf16 v[60:63], a[40:43], a[192:195], v[60:63]
    ds_read_b128 a[176:179], v138 offset:2048
    ds_read_b128 v[192:195], v22 offset:768
    v_mfma_f32_16x16x32_bf16 v[64:67], a[44:47], a[192:195], v[64:67]
    buffer_load_dwordx4 v13, s[4:7], s20 offen offset:3072 lds
    v_mfma_f32_16x16x32_bf16 v[68:71], a[40:43], a[196:199], v[68:71]
    ds_read_b128 v[196:199], v22 offset:1024
    v_mfma_f32_16x16x32_bf16 v[72:75], a[44:47], a[196:199], v[72:75]
    s_waitcnt lgkmcnt(0)
    v_mfma_f32_16x16x32_bf16 v[36:39], a[48:51], a[160:163], v[36:39]
    ds_read_b128 a[56:59], v137 offset:0
    s_add_u32 m0, s76, 61440
    s_nop 0
    v_mfma_f32_16x16x32_bf16 v[40:43], a[52:55], a[160:163], v[40:43]
    ds_read_b128 a[60:63], v137 offset:2048
    buffer_load_dwordx4 v17, s[8:11], s20 offen offset:0 lds
    v_mfma_f32_16x16x32_bf16 v[44:47], a[48:51], a[164:167], v[44:47]
    ds_read_b128 a[180:183], v139 offset:0
    v_mfma_f32_16x16x32_bf16 v[48:51], a[52:55], a[164:167], v[48:51]
    ds_read_b128 a[184:187], v139 offset:14336
    v_mfma_f32_16x16x32_bf16 v[52:55], a[48:51], a[168:171], v[52:55]
    ds_read_b128 a[188:191], v139 offset:1024
    buffer_load_dwordx4 v18, s[8:11], s20 offen offset:1024 lds
    v_mfma_f32_16x16x32_bf16 v[56:59], a[52:55], a[168:171], v[56:59]
    ds_read_b128 a[192:195], v139 offset:15360
    v_mfma_f32_16x16x32_bf16 v[60:63], a[48:51], a[172:175], v[60:63]
    ds_read_b128 a[196:199], v139 offset:2048
    v_mfma_f32_16x16x32_bf16 v[64:67], a[52:55], a[172:175], v[64:67]
    buffer_load_dwordx4 v19, s[8:11], s20 offen offset:2048 lds
    v_mfma_f32_16x16x32_bf16 v[68:71], a[48:51], a[176:179], v[68:71]
    v_mfma_f32_16x16x32_bf16 v[72:75], a[52:55], a[176:179], v[72:75]
    s_waitcnt vmcnt(8) lgkmcnt(0)
    s_barrier
    v_mfma_f32_16x16x32_bf16 v[36:39], a[56:59], a[180:183], v[36:39]
    ds_read_b128 a[64:67], v136 offset:28672
    s_add_u32 s20, s20, 128
    s_cmp_eq_u32 s20, 1280
    s_cselect_b32 s20, 0, s20
    s_add_u32 m0, s76, 0
    s_nop 0
    v_mfma_f32_16x16x32_bf16 v[40:43], a[60:63], a[180:183], v[40:43]
    ds_read_b128 a[68:71], v136 offset:30720
    buffer_load_dwordx4 v10, s[4:7], s20 offen offset:0 lds
    v_mfma_f32_16x16x32_bf16 v[44:47], a[56:59], a[184:187], v[44:47]
    ds_read_b128 a[160:163], v138 offset:28672
    v_mfma_f32_16x16x32_bf16 v[48:51], a[60:63], a[184:187], v[48:51]
    ds_read_b128 a[164:167], v138 offset:43008
    buffer_load_dwordx4 v11, s[4:7], s20 offen offset:1024 lds
    v_mfma_f32_16x16x32_bf16 v[52:55], a[56:59], a[188:191], v[52:55]
    ds_read_b128 a[168:171], v138 offset:29696
    v_mfma_f32_16x16x32_bf16 v[56:59], a[60:63], a[188:191], v[56:59]
    ds_read_b128 a[172:175], v138 offset:44032
    buffer_load_dwordx4 v12, s[4:7], s20 offen offset:2048 lds
    v_mfma_f32_16x16x32_bf16 v[60:63], a[56:59], a[192:195], v[60:63]
    ds_read_b128 a[176:179], v138 offset:30720
    v_mfma_f32_16x16x32_bf16 v[64:67], a[60:63], a[192:195], v[64:67]
    buffer_load_dwordx4 v13, s[4:7], s20 offen offset:3072 lds
    v_mfma_f32_16x16x32_bf16 v[68:71], a[56:59], a[196:199], v[68:71]
    v_mfma_f32_16x16x32_bf16 v[72:75], a[60:63], a[196:199], v[72:75]
    s_waitcnt lgkmcnt(0)
    v_mfma_f32_16x16x32_bf16 v[36:39], a[64:67], a[160:163], v[36:39]
    ds_read_b128 a[72:75], v137 offset:28672
    s_add_u32 m0, s76, 4096
    s_nop 0
    v_mfma_f32_16x16x32_bf16 v[40:43], a[68:71], a[160:163], v[40:43]
    ds_read_b128 a[76:79], v137 offset:30720
    buffer_load_dwordx4 v17, s[8:11], s20 offen offset:0 lds
    v_mfma_f32_16x16x32_bf16 v[44:47], a[64:67], a[164:167], v[44:47]
    ds_read_b128 a[180:183], v139 offset:28672
    v_mfma_f32_16x16x32_bf16 v[48:51], a[68:71], a[164:167], v[48:51]
    ds_read_b128 a[184:187], v139 offset:43008
    v_mfma_f32_16x16x32_bf16 v[52:55], a[64:67], a[168:171], v[52:55]
    ds_read_b128 a[188:191], v139 offset:29696
    buffer_load_dwordx4 v18, s[8:11], s20 offen offset:1024 lds
    v_mfma_f32_16x16x32_bf16 v[56:59], a[68:71], a[168:171], v[56:59]
    ds_read_b128 a[192:195], v139 offset:44032
    v_mfma_f32_16x16x32_bf16 v[60:63], a[64:67], a[172:175], v[60:63]
    ds_read_b128 a[196:199], v139 offset:30720
    v_mfma_f32_16x16x32_bf16 v[64:67], a[68:71], a[172:175], v[64:67]
    buffer_load_dwordx4 v19, s[8:11], s20 offen offset:2048 lds
    v_mfma_f32_16x16x32_bf16 v[68:71], a[64:67], a[176:179], v[68:71]
    v_mfma_f32_16x16x32_bf16 v[72:75], a[68:71], a[176:179], v[72:75]
    s_waitcnt vmcnt(7) lgkmcnt(0)
    s_barrier
    v_mfma_f32_16x16x32_bf16 v[36:39], a[72:75], a[180:183], v[36:39]
    ds_read_b128 a[80:83], v136 offset:57344
    s_add_u32 s20, s20, 128
    s_cmp_eq_u32 s20, 1280
    s_cselect_b32 s20, 0, s20
    s_add_u32 m0, s76, 28672
    s_nop 0
    v_mfma_f32_16x16x32_bf16 v[40:43], a[76:79], a[180:183], v[40:43]
    ds_read_b128 a[84:87], v136 offset:59392
    buffer_load_dwordx4 v10, s[4:7], s20 offen offset:0 lds
    v_mfma_f32_16x16x32_bf16 v[44:47], a[72:75], a[184:187], v[44:47]
    ds_read_b128 a[160:163], v140 offset:0
    v_mfma_f32_16x16x32_bf16 v[48:51], a[76:79], a[184:187], v[48:51]
    ds_read_b128 a[164:167], v140 offset:14336
    buffer_load_dwordx4 v11, s[4:7], s20 offen offset:1024 lds
    v_mfma_f32_16x16x32_bf16 v[52:55], a[72:75], a[188:191], v[52:55]
    ds_read_b128 a[168:171], v140 offset:1024
    v_mfma_f32_16x16x32_bf16 v[56:59], a[76:79], a[188:191], v[56:59]
    ds_read_b128 a[172:175], v140 offset:15360
    buffer_load_dwordx4 v12, s[4:7], s20 offen offset:2048 lds
    v_mfma_f32_16x16x32_bf16 v[60:63], a[72:75], a[192:195], v[60:63]
    ds_read_b128 a[176:179], v140 offset:2048
    v_mfma_f32_16x16x32_bf16 v[64:67], a[76:79], a[192:195], v[64:67]
    buffer_load_dwordx4 v13, s[4:7], s20 offen offset:3072 lds
    v_mfma_f32_16x16x32_bf16 v[68:71], a[72:75], a[196:199], v[68:71]
    v_mfma_f32_16x16x32_bf16 v[72:75], a[76:79], a[196:199], v[72:75]
    s_waitcnt lgkmcnt(0)
    v_mfma_f32_16x16x32_bf16 v[36:39], a[80:83], a[160:163], v[36:39]
    ds_read_b128 a[88:91], v137 offset:57344
    s_add_u32 m0, s76, 32768
    s_nop 0
    v_mfma_f32_16x16x32_bf16 v[40:43], a[84:87], a[160:163], v[40:43]
    ds_read_b128 a[92:95], v137 offset:59392
    buffer_load_dwordx4 v17, s[8:11], s20 offen offset:0 lds
    v_mfma_f32_16x16x32_bf16 v[44:47], a[80:83], a[164:167], v[44:47]
    ds_read_b128 a[180:183], v141 offset:0
    v_mfma_f32_16x16x32_bf16 v[48:51], a[84:87], a[164:167], v[48:51]
    ds_read_b128 a[184:187], v141 offset:14336
    v_mfma_f32_16x16x32_bf16 v[52:55], a[80:83], a[168:171], v[52:55]
    ds_read_b128 a[188:191], v141 offset:1024
    buffer_load_dwordx4 v18, s[8:11], s20 offen offset:1024 lds
    v_mfma_f32_16x16x32_bf16 v[56:59], a[84:87], a[168:171], v[56:59]
    ds_read_b128 a[192:195], v141 offset:15360
    v_mfma_f32_16x16x32_bf16 v[60:63], a[80:83], a[172:175], v[60:63]
    ds_read_b128 a[196:199], v141 offset:2048
    v_mfma_f32_16x16x32_bf16 v[64:67], a[84:87], a[172:175], v[64:67]
    buffer_load_dwordx4 v19, s[8:11], s20 offen offset:2048 lds
    v_mfma_f32_16x16x32_bf16 v[68:71], a[80:83], a[176:179], v[68:71]
    v_mfma_f32_16x16x32_bf16 v[72:75], a[84:87], a[176:179], v[72:75]
    s_waitcnt vmcnt(7) lgkmcnt(0)
    s_barrier
    v_mfma_f32_16x16x32_bf16 v[36:39], a[88:91], a[180:183], v[36:39]
    ds_read_b128 a[96:99], v136 offset:0
    s_add_u32 s20, s20, 128
    s_cmp_eq_u32 s20, 1280
    s_cselect_b32 s20, 0, s20
    s_add_u32 m0, s76, 57344
    s_nop 0
    v_mfma_f32_16x16x32_bf16 v[40:43], a[92:95], a[180:183], v[40:43]
    ds_read_b128 a[100:103], v136 offset:2048
    buffer_load_dwordx4 v10, s[4:7], s20 offen offset:0 lds
    v_mfma_f32_16x16x32_bf16 v[44:47], a[88:91], a[184:187], v[44:47]
    ds_read_b128 a[160:163], v138 offset:0
    v_mfma_f32_16x16x32_bf16 v[48:51], a[92:95], a[184:187], v[48:51]
    ds_read_b128 a[164:167], v138 offset:14336
    buffer_load_dwordx4 v11, s[4:7], s20 offen offset:1024 lds
    v_mfma_f32_16x16x32_bf16 v[52:55], a[88:91], a[188:191], v[52:55]
    ds_read_b128 a[168:171], v138 offset:1024
    v_mfma_f32_16x16x32_bf16 v[56:59], a[92:95], a[188:191], v[56:59]
    ds_read_b128 a[172:175], v138 offset:15360
    buffer_load_dwordx4 v12, s[4:7], s20 offen offset:2048 lds
    v_mfma_f32_16x16x32_bf16 v[60:63], a[88:91], a[192:195], v[60:63]
    ds_read_b128 a[176:179], v138 offset:2048
    v_mfma_f32_16x16x32_bf16 v[64:67], a[92:95], a[192:195], v[64:67]
    buffer_load_dwordx4 v13, s[4:7], s20 offen offset:3072 lds
    v_mfma_f32_16x16x32_bf16 v[68:71], a[88:91], a[196:199], v[68:71]
    v_mfma_f32_16x16x32_bf16 v[72:75], a[92:95], a[196:199], v[72:75]
    s_waitcnt lgkmcnt(0)
    v_mfma_f32_16x16x32_bf16 v[36:39], a[96:99], a[160:163], v[36:39]
    ds_read_b128 a[104:107], v137 offset:0
    s_add_u32 m0, s76, 61440
    s_nop 0
    v_mfma_f32_16x16x32_bf16 v[40:43], a[100:103], a[160:163], v[40:43]
    ds_read_b128 a[108:111], v137 offset:2048
    buffer_load_dwordx4 v17, s[8:11], s20 offen offset:0 lds
    v_mfma_f32_16x16x32_bf16 v[44:47], a[96:99], a[164:167], v[44:47]
    ds_read_b128 a[180:183], v139 offset:0
    v_mfma_f32_16x16x32_bf16 v[48:51], a[100:103], a[164:167], v[48:51]
    ds_read_b128 a[184:187], v139 offset:14336
    v_mfma_f32_16x16x32_bf16 v[52:55], a[96:99], a[168:171], v[52:55]
    ds_read_b128 a[188:191], v139 offset:1024
    buffer_load_dwordx4 v18, s[8:11], s20 offen offset:1024 lds
    v_mfma_f32_16x16x32_bf16 v[56:59], a[100:103], a[168:171], v[56:59]
    ds_read_b128 a[192:195], v139 offset:15360
    v_mfma_f32_16x16x32_bf16 v[60:63], a[96:99], a[172:175], v[60:63]
    ds_read_b128 a[196:199], v139 offset:2048
    v_mfma_f32_16x16x32_bf16 v[64:67], a[100:103], a[172:175], v[64:67]
    buffer_load_dwordx4 v19, s[8:11], s20 offen offset:2048 lds
    v_mfma_f32_16x16x32_bf16 v[68:71], a[96:99], a[176:179], v[68:71]
    v_mfma_f32_16x16x32_bf16 v[72:75], a[100:103], a[176:179], v[72:75]
    s_waitcnt vmcnt(7) lgkmcnt(0)
    s_barrier
    v_mfma_f32_16x16x32_bf16 v[36:39], a[104:107], a[180:183], v[36:39]
    ds_read_b128 a[112:115], v136 offset:28672
    s_add_u32 s20, s20, 128
    s_cmp_eq_u32 s20, 1280
    s_cselect_b32 s20, 0, s20
    s_add_u32 m0, s76, 0
    s_nop 0
    s_lshl_b32 s32, s28, 9
    v_mfma_f32_16x16x32_bf16 v[40:43], a[108:111], a[180:183], v[40:43]
    ds_read_b128 a[116:119], v136 offset:30720
    buffer_load_dwordx4 v10, s[4:7], s20 offen offset:0 lds
    s_lshl_b32 s33, s27, 7
    v_mfma_f32_16x16x32_bf16 v[44:47], a[104:107], a[184:187], v[44:47]
    ds_read_b128 a[160:163], v138 offset:28672
    s_add_u32 s32, s32, s33
    v_mfma_f32_16x16x32_bf16 v[48:51], a[108:111], a[184:187], v[48:51]
    ds_read_b128 a[164:167], v138 offset:43008
    buffer_load_dwordx4 v11, s[4:7], s20 offen offset:1024 lds
    s_add_u32 s32, s32, 21118976
    v_mfma_f32_16x16x32_bf16 v[52:55], a[104:107], a[188:191], v[52:55]
    ds_read_b128 a[168:171], v138 offset:29696
    s_add_u32 s33, s32, 8192
    v_mfma_f32_16x16x32_bf16 v[56:59], a[108:111], a[188:191], v[56:59]
    ds_read_b128 a[172:175], v138 offset:44032
    buffer_load_dwordx4 v12, s[4:7], s20 offen offset:2048 lds
    s_mul_i32 s34, s29, 320
    v_mfma_f32_16x16x32_bf16 v[60:63], a[104:107], a[192:195], v[60:63]
    ds_read_b128 a[176:179], v138 offset:30720
    s_add_u32 s34, s34, 21135360
    v_mfma_f32_16x16x32_bf16 v[64:67], a[108:111], a[192:195], v[64:67]
    buffer_load_dwordx4 v13, s[4:7], s20 offen offset:3072 lds
    s_mov_b32 s78, 21118976
    v_mfma_f32_16x16x32_bf16 v[68:71], a[104:107], a[196:199], v[68:71]
    s_mov_b32 s79, 21127168
    v_mfma_f32_16x16x32_bf16 v[72:75], a[108:111], a[196:199], v[72:75]
    s_waitcnt lgkmcnt(0)
    v_mfma_f32_16x16x32_bf16 v[36:39], a[112:115], a[160:163], v[36:39]
    ds_read_b128 a[120:123], v137 offset:28672
    s_add_u32 m0, s76, 4096
    s_nop 0
    v_mfma_f32_16x16x32_bf16 v[40:43], a[116:119], a[160:163], v[40:43]
    ds_read_b128 a[124:127], v137 offset:30720
    buffer_load_dwordx4 v17, s[8:11], s20 offen offset:0 lds
    v_mfma_f32_16x16x32_bf16 v[44:47], a[112:115], a[164:167], v[44:47]
    ds_read_b128 a[180:183], v139 offset:28672
    v_mfma_f32_16x16x32_bf16 v[48:51], a[116:119], a[164:167], v[48:51]
    ds_read_b128 a[184:187], v139 offset:43008
    v_mfma_f32_16x16x32_bf16 v[52:55], a[112:115], a[168:171], v[52:55]
    ds_read_b128 a[188:191], v139 offset:29696
    buffer_load_dwordx4 v18, s[8:11], s20 offen offset:1024 lds
    v_mfma_f32_16x16x32_bf16 v[56:59], a[116:119], a[168:171], v[56:59]
    ds_read_b128 a[192:195], v139 offset:44032
    v_mfma_f32_16x16x32_bf16 v[60:63], a[112:115], a[172:175], v[60:63]
    ds_read_b128 a[196:199], v139 offset:30720
    v_mfma_f32_16x16x32_bf16 v[64:67], a[116:119], a[172:175], v[64:67]
    buffer_load_dwordx4 v19, s[8:11], s20 offen offset:2048 lds
    v_mfma_f32_16x16x32_bf16 v[68:71], a[112:115], a[176:179], v[68:71]
    v_mfma_f32_16x16x32_bf16 v[72:75], a[116:119], a[176:179], v[72:75]
    s_cmp_lg_u32 s27, 0
    s_cbranch_scc1 L_nof0ld
    global_load_dword v25, v24, s[62:63] sc1
    s_branch L_f0ld_end
L_nof0ld:
    buffer_load_dword v21, v20, s[4:7], 0 offen
L_f0ld_end:
    s_waitcnt vmcnt(8) lgkmcnt(0)
    s_barrier
    v_mfma_f32_16x16x32_bf16 v[36:39], a[120:123], a[180:183], v[36:39]
    ds_read_b128 a[128:131], v136 offset:57344
    s_add_u32 m0, s22, 86016
    s_mul_i32 s21, s23, 1536
    v_mfma_f32_16x16x32_bf16 v[40:43], a[124:127], a[180:183], v[40:43]
    ds_read_b128 a[132:135], v136 offset:59392
    buffer_load_dwordx4 v14, s[16:19], s21 offen offset:0 lds
    v_mfma_f32_16x16x32_bf16 v[44:47], a[120:123], a[184:187], v[44:47]
    ds_read_b128 a[160:163], v140 offset:0
    v_mfma_f32_16x16x32_bf16 v[48:51], a[124:127], a[184:187], v[48:51]
    ds_read_b128 a[164:167], v140 offset:14336
    v_mfma_f32_16x16x32_bf16 v[52:55], a[120:123], a[188:191], v[52:55]
    ds_read_b128 a[168:171], v140 offset:1024
    buffer_load_dwordx4 v15, s[16:19], s21 offen offset:1024 lds
    v_mfma_f32_16x16x32_bf16 v[56:59], a[124:127], a[188:191], v[56:59]
    ds_read_b128 a[172:175], v140 offset:15360
    v_mfma_f32_16x16x32_bf16 v[60:63], a[120:123], a[192:195], v[60:63]
    ds_read_b128 a[176:179], v140 offset:2048
    v_mfma_f32_16x16x32_bf16 v[64:67], a[124:127], a[192:195], v[64:67]
    buffer_load_dwordx4 v16, s[16:19], s21 offen offset:2048 lds
    v_mfma_f32_16x16x32_bf16 v[68:71], a[120:123], a[196:199], v[68:71]
    v_mfma_f32_16x16x32_bf16 v[72:75], a[124:127], a[196:199], v[72:75]
    s_waitcnt lgkmcnt(0)
    v_mfma_f32_16x16x32_bf16 v[36:39], a[128:131], a[160:163], v[36:39]
    ds_read_b128 a[136:139], v137 offset:57344
    s_add_u32 s23, s23, 128
    s_cmp_eq_u32 s23, 1280
    s_cselect_b32 s23, 0, s23
    s_add_u32 m0, s22, 98304
    s_mul_i32 s21, s23, 1536
    v_mfma_f32_16x16x32_bf16 v[40:43], a[132:135], a[160:163], v[40:43]
    ds_read_b128 a[140:143], v137 offset:59392
    buffer_load_dwordx4 v14, s[16:19], s21 offen offset:0 lds
    v_mfma_f32_16x16x32_bf16 v[44:47], a[128:131], a[164:167], v[44:47]
    ds_read_b128 a[180:183], v141 offset:0
    v_mfma_f32_16x16x32_bf16 v[48:51], a[132:135], a[164:167], v[48:51]
    ds_read_b128 a[184:187], v141 offset:14336
    v_mfma_f32_16x16x32_bf16 v[52:55], a[128:131], a[168:171], v[52:55]
    ds_read_b128 a[188:191], v141 offset:1024
    buffer_load_dwordx4 v15, s[16:19], s21 offen offset:1024 lds
    v_mfma_f32_16x16x32_bf16 v[56:59], a[132:135], a[168:171], v[56:59]
    ds_read_b128 a[192:195], v141 offset:15360
    v_mfma_f32_16x16x32_bf16 v[60:63], a[128:131], a[172:175], v[60:63]
    ds_read_b128 a[196:199], v141 offset:2048
    v_mfma_f32_16x16x32_bf16 v[64:67], a[132:135], a[172:175], v[64:67]
    buffer_load_dwordx4 v16, s[16:19], s21 offen offset:2048 lds
    v_mfma_f32_16x16x32_bf16 v[68:71], a[128:131], a[176:179], v[68:71]
    v_mfma_f32_16x16x32_bf16 v[72:75], a[132:135], a[176:179], v[72:75]
    s_cmp_lg_u32 s27, 0
    s_cbranch_scc1 L_nof0
    s_mov_b32 s3, 0
    s_waitcnt vmcnt(6)
L_f0:
    v_cmp_gt_u32 vcc, 64, v25
    s_add_u32 s3, s3, 1
    s_cmp_eq_u64 vcc, 0
    s_cbranch_scc1 L_nof0
    s_cmp_gt_u32 s3, 200000
    s_cbranch_scc1 L_nof0
    s_sleep 10
    global_load_dword v25, v24, s[62:63] sc1
    s_waitcnt vmcnt(0)
    s_branch L_f0
L_nof0:
    s_waitcnt vmcnt(7) lgkmcnt(0)
    s_barrier
    v_mfma_f32_16x16x32_bf16 v[36:39], a[136:139], a[180:183], v[36:39]
    ds_read_b128 a[144:147], v136 offset:0
    v_mfma_f32_16x16x32_bf16 v[40:43], a[140:143], a[180:183], v[40:43]
    ds_read_b128 a[148:151], v136 offset:2048
    buffer_load_dwordx4 v[152:155], v120, s[12:15], s32 offen offset:0 sc1
    buffer_load_dwordx4 v[156:159], v120, s[12:15], s32 offen offset:16 sc1
    v_mfma_f32_16x16x32_bf16 v[44:47], a[136:139], a[184:187], v[44:47]
    ds_read_b128 a[160:163], v138 offset:0
    buffer_load_dword v172, v122, s[12:15], s34 offen offset:0 sc1
    buffer_load_dword v173, v122, s[12:15], s34 offen offset:64 sc1
    v_mfma_f32_16x16x32_bf16 v[48:51], a[140:143], a[184:187], v[48:51]
    ds_read_b128 a[164:167], v138 offset:14336
    buffer_load_dword v174, v122, s[12:15], s34 offen offset:128 sc1
    v_mfma_f32_16x16x32_bf16 v[52:55], a[136:139], a[188:191], v[52:55]
    ds_read_b128 a[168:171], v138 offset:1024
    buffer_load_dword v175, v122, s[12:15], s34 offen offset:192 sc1
    buffer_load_dword v176, v122, s[12:15], s34 offen offset:256 sc1
    v_mfma_f32_16x16x32_bf16 v[56:59], a[140:143], a[188:191], v[56:59]
    ds_read_b128 a[172:175], v138 offset:15360
    buffer_load_dwordx4 v[160:163], v120, s[12:15], s33 offen offset:0 sc1
    buffer_load_dwordx4 v[164:167], v120, s[12:15], s33 offen offset:16 sc1
    v_mfma_f32_16x16x32_bf16 v[60:63], a[136:139], a[192:195], v[60:63]
    ds_read_b128 a[176:179], v138 offset:2048
    buffer_load_dword v252, v123, s[12:15], s78 offen sc1
    v_mfma_f32_16x16x32_bf16 v[64:67], a[140:143], a[192:195], v[64:67]
    buffer_load_dword v253, v123, s[12:15], s79 offen sc1
    buffer_load_dword v168, v121, s[12:15], s32 offen offset:0 sc1
    v_mfma_f32_16x16x32_bf16 v[68:71], a[136:139], a[196:199], v[68:71]
    buffer_load_dword v169, v121, s[12:15], s32 offen offset:16 sc1
    buffer_load_dword v170, v121, s[12:15], s33 offen offset:0 sc1
    v_mfma_f32_16x16x32_bf16 v[72:75], a[140:143], a[196:199], v[72:75]
    buffer_load_dword v171, v121, s[12:15], s33 offen offset:16 sc1
    s_waitcnt lgkmcnt(0)
    v_mfma_f32_16x16x32_bf16 v[36:39], a[144:147], a[160:163], v[36:39]
    ds_read_b128 a[152:155], v137 offset:0
    s_add_u32 s23, s23, 128
    s_cmp_eq_u32 s23, 1280
    s_cselect_b32 s23, 0, s23
    s_add_u32 m0, s22, 110592
    s_mul_i32 s21, s23, 1536
    s_mul_i32 s32, s29, 5120
    v_mfma_f32_16x16x32_bf16 v[40:43], a[148:151], a[160:163], v[40:43]
    ds_read_b128 a[156:159], v137 offset:2048
    buffer_load_dwordx4 v14, s[16:19], s21 offen offset:0 lds
    v_mfma_f32_16x16x32_bf16 v[44:47], a[144:147], a[164:167], v[44:47]
    ds_read_b128 a[180:183], v139 offset:0
    s_add_u32 s32, s32, 20971520
    v_mfma_f32_16x16x32_bf16 v[48:51], a[148:151], a[164:167], v[48:51]
    ds_read_b128 a[184:187], v139 offset:14336
    v_mfma_f32_16x16x32_bf16 v[52:55], a[144:147], a[168:171], v[52:55]
    ds_read_b128 a[188:191], v139 offset:1024
    buffer_load_dwordx4 v15, s[16:19], s21 offen offset:1024 lds
    s_add_u32 s8, s64, s32
    s_addc_u32 s9, s65, 0
    v_mfma_f32_16x16x32_bf16 v[56:59], a[148:151], a[168:171], v[56:59]
    ds_read_b128 a[192:195], v139 offset:15360
    v_mfma_f32_16x16x32_bf16 v[60:63], a[144:147], a[172:175], v[60:63]
    ds_read_b128 a[196:199], v139 offset:2048
    s_mov_b32 s10, 5120
    v_mfma_f32_16x16x32_bf16 v[64:67], a[148:151], a[172:175], v[64:67]
    buffer_load_dwordx4 v16, s[16:19], s21 offen offset:2048 lds
    v_mfma_f32_16x16x32_bf16 v[68:71], a[144:147], a[176:179], v[68:71]
    v_mov_b32 v1, 0x7fc00000
    v_mfma_f32_16x16x32_bf16 v[72:75], a[148:151], a[176:179], v[72:75]
    s_waitcnt lgkmcnt(0)
    v_mfma_f32_16x16x32_bf16 v[36:39], a[152:155], a[180:183], v[36:39]
    s_add_u32 s23, s23, 128
    s_cmp_eq_u32 s23, 1280
    s_cselect_b32 s23, 0, s23
    s_add_u32 m0, s22, 122880
    s_mul_i32 s21, s23, 1536
    v_mfma_f32_16x16x32_bf16 v[40:43], a[156:159], a[180:183], v[40:43]
    buffer_load_dwordx4 v14, s[16:19], s21 offen offset:0 lds
    v_mfma_f32_16x16x32_bf16 v[44:47], a[152:155], a[184:187], v[44:47]
    v_mfma_f32_16x16x32_bf16 v[48:51], a[156:159], a[184:187], v[48:51]
    v_mfma_f32_16x16x32_bf16 v[52:55], a[152:155], a[188:191], v[52:55]
    buffer_load_dwordx4 v15, s[16:19], s21 offen offset:1024 lds
    v_mfma_f32_16x16x32_bf16 v[56:59], a[156:159], a[188:191], v[56:59]
    v_mfma_f32_16x16x32_bf16 v[60:63], a[152:155], a[192:195], v[60:63]
    v_mfma_f32_16x16x32_bf16 v[64:67], a[156:159], a[192:195], v[64:67]
    buffer_load_dwordx4 v16, s[16:19], s21 offen offset:2048 lds
    v_mfma_f32_16x16x32_bf16 v[68:71], a[152:155], a[196:199], v[68:71]
    v_mfma_f32_16x16x32_bf16 v[72:75], a[156:159], a[196:199], v[72:75]
    s_waitcnt vmcnt(6)
    v_pk_fma_f32 v[36:37], v[152:153], v[172:173], v[36:37] op_sel:[0,0,0] op_sel_hi:[1,0,1] neg_lo:[0,1,0] neg_hi:[0,1,0]
    v_pk_fma_f32 v[38:39], v[154:155], v[172:173], v[38:39] op_sel:[0,0,0] op_sel_hi:[1,0,1] neg_lo:[0,1,0] neg_hi:[0,1,0]
    v_pk_fma_f32 v[40:41], v[156:157], v[172:173], v[40:41] op_sel:[0,0,0] op_sel_hi:[1,0,1] neg_lo:[0,1,0] neg_hi:[0,1,0]
    v_pk_fma_f32 v[42:43], v[158:159], v[172:173], v[42:43] op_sel:[0,0,0] op_sel_hi:[1,0,1] neg_lo:[0,1,0] neg_hi:[0,1,0]
    v_pk_mul_f32 v[36:37], v[36:37], v[160:161]
    v_pk_mul_f32 v[38:39], v[38:39], v[162:163]
    v_pk_mul_f32 v[40:41], v[40:41], v[164:165]
    v_pk_mul_f32 v[42:43], v[42:43], v[166:167]
    v_pk_fma_f32 v[44:45], v[152:153], v[172:173], v[44:45] op_sel:[0,1,0] op_sel_hi:[1,1,1] neg_lo:[0,1,0] neg_hi:[0,1,0]
    v_pk_fma_f32 v[46:47], v[154:155], v[172:173], v[46:47] op_sel:[0,1,0] op_sel_hi:[1,1,1] neg_lo:[0,1,0] neg_hi:[0,1,0]
    v_pk_fma_f32 v[48:49], v[156:157], v[172:173], v[48:49] op_sel:[0,1,0] op_sel_hi:[1,1,1] neg_lo:[0,1,0] neg_hi:[0,1,0]
    v_pk_fma_f32 v[50:51], v[158:159], v[172:173], v[50:51] op_sel:[0,1,0] op_sel_hi:[1,1,1] neg_lo:[0,1,0] neg_hi:[0,1,0]
    v_pk_mul_f32 v[44:45], v[44:45], v[160:161]
    v_pk_mul_f32 v[46:47], v[46:47], v[162:163]
    v_pk_mul_f32 v[48:49], v[48:49], v[164:165]
    v_pk_mul_f32 v[50:51], v[50:51], v[166:167]
    v_pk_fma_f32 v[52:53], v[152:153], v[174:175], v[52:53] op_sel:[0,0,0] op_sel_hi:[1,0,1] neg_lo:[0,1,0] neg_hi:[0,1,0]
    v_pk_fma_f32 v[54:55], v[154:155], v[174:175], v[54:55] op_sel:[0,0,0] op_sel_hi:[1,0,1] neg_lo:[0,1,0] neg_hi:[0,1,0]
    v_pk_fma_f32 v[56:57], v[156:157], v[174:175], v[56:57] op_sel:[0,0,0] op_sel_hi:[1,0,1] neg_lo:[0,1,0] neg_hi:[0,1,0]
    v_pk_fma_f32 v[58:59], v[158:159], v[174:175], v[58:59] op_sel:[0,0,0] op_sel_hi:[1,0,1] neg_lo:[0,1,0] neg_hi:[0,1,0]
    v_pk_mul_f32 v[52:53], v[52:53], v[160:161]
    v_pk_mul_f32 v[54:55], v[54:55], v[162:163]
    v_pk_mul_f32 v[56:57], v[56:57], v[164:165]
    v_pk_mul_f32 v[58:59], v[58:59], v[166:167]
    v_pk_fma_f32 v[60:61], v[152:153], v[174:175], v[60:61] op_sel:[0,1,0] op_sel_hi:[1,1,1] neg_lo:[0,1,0] neg_hi:[0,1,0]
    v_pk_fma_f32 v[62:63], v[154:155], v[174:175], v[62:63] op_sel:[0,1,0] op_sel_hi:[1,1,1] neg_lo:[0,1,0] neg_hi:[0,1,0]
    v_pk_fma_f32 v[64:65], v[156:157], v[174:175], v[64:65] op_sel:[0,1,0] op_sel_hi:[1,1,1] neg_lo:[0,1,0] neg_hi:[0,1,0]
    v_pk_fma_f32 v[66:67], v[158:159], v[174:175], v[66:67] op_sel:[0,1,0] op_sel_hi:[1,1,1] neg_lo:[0,1,0] neg_hi:[0,1,0]
    v_pk_mul_f32 v[60:61], v[60:61], v[160:161]
    v_pk_mul_f32 v[62:63], v[62:63], v[162:163]
    v_pk_mul_f32 v[64:65], v[64:65], v[164:165]
    v_pk_mul_f32 v[66:67], v[66:67], v[166:167]
    v_pk_fma_f32 v[68:69], v[152:153], v[176:177], v[68:69] op_sel:[0,0,0] op_sel_hi:[1,0,1] neg_lo:[0,1,0] neg_hi:[0,1,0]
    v_pk_fma_f32 v[70:71], v[154:155], v[176:177], v[70:71] op_sel:[0,0,0] op_sel_hi:[1,0,1] neg_lo:[0,1,0] neg_hi:[0,1,0]
    v_pk_fma_f32 v[72:73], v[156:157], v[176:177], v[72:73] op_sel:[0,0,0] op_sel_hi:[1,0,1] neg_lo:[0,1,0] neg_hi:[0,1,0]
    v_pk_fma_f32 v[74:75], v[158:159], v[176:177], v[74:75] op_sel:[0,0,0] op_sel_hi:[1,0,1] neg_lo:[0,1,0] neg_hi:[0,1,0]
    v_pk_mul_f32 v[68:69], v[68:69], v[160:161]
    v_pk_mul_f32 v[70:71], v[70:71], v[162:163]
    v_pk_mul_f32 v[72:73], v[72:73], v[164:165]
    v_pk_mul_f32 v[74:75], v[74:75], v[166:167]
    v_fma_f32 v205, v180, v36, v37
    v_fma_f32 v206, v184, v44, v45
    v_fma_f32 v207, v188, v52, v53
    v_fma_f32 v208, v192, v60, v61
    v_fma_f32 v209, v196, v68, v69
    v_fmac_f32_dpp v205, v36, v181 row_ror:8 row_mask:0xf bank_mask:0xf
    v_fmac_f32_dpp v206, v44, v185 row_ror:8 row_mask:0xf bank_mask:0xf
    v_fmac_f32_dpp v207, v52, v189 row_ror:8 row_mask:0xf bank_mask:0xf
    v_fmac_f32_dpp v208, v60, v193 row_ror:8 row_mask:0xf bank_mask:0xf
    v_fmac_f32_dpp v209, v68, v197 row_ror:8 row_mask:0xf bank_mask:0xf
    v_fma_f32 v200, v180, v205, v38
    v_fma_f32 v201, v184, v206, v46
    v_fma_f32 v202, v188, v207, v54
    v_fma_f32 v203, v192, v208, v62
    v_fma_f32 v204, v196, v209, v70
    v_fmac_f32_dpp v200, v205, v181 row_ror:8 row_mask:0xf bank_mask:0xf
    v_fmac_f32_dpp v201, v206, v185 row_ror:8 row_mask:0xf bank_mask:0xf
    v_fmac_f32_dpp v202, v207, v189 row_ror:8 row_mask:0xf bank_mask:0xf
    v_fmac_f32_dpp v203, v208, v193 row_ror:8 row_mask:0xf bank_mask:0xf
    v_fmac_f32_dpp v204, v209, v197 row_ror:8 row_mask:0xf bank_mask:0xf
    v_fma_f32 v205, v180, v200, v39
    v_fma_f32 v206, v184, v201, v47
    v_fma_f32 v207, v188, v202, v55
    v_fma_f32 v208, v192, v203, v63
    v_fma_f32 v209, v196, v204, v71
    v_fmac_f32_dpp v205, v200, v181 row_ror:8 row_mask:0xf bank_mask:0xf
    v_fmac_f32_dpp v206, v201, v185 row_ror:8 row_mask:0xf bank_mask:0xf
    v_fmac_f32_dpp v207, v202, v189 row_ror:8 row_mask:0xf bank_mask:0xf
    v_fmac_f32_dpp v208, v203, v193 row_ror:8 row_mask:0xf bank_mask:0xf
    v_fmac_f32_dpp v209, v204, v197 row_ror:8 row_mask:0xf bank_mask:0xf
    v_fma_f32 v200, v180, v205, v40
    v_fma_f32 v201, v184, v206, v48
    v_fma_f32 v202, v188, v207, v56
    v_fma_f32 v203, v192, v208, v64
    v_fma_f32 v204, v196, v209, v72
    v_fmac_f32_dpp v200, v205, v181 row_ror:8 row_mask:0xf bank_mask:0xf
    v_fmac_f32_dpp v201, v206, v185 row_ror:8 row_mask:0xf bank_mask:0xf
    v_fmac_f32_dpp v202, v207, v189 row_ror:8 row_mask:0xf bank_mask:0xf
    v_fmac_f32_dpp v203, v208, v193 row_ror:8 row_mask:0xf bank_mask:0xf
    v_fmac_f32_dpp v204, v209, v197 row_ror:8 row_mask:0xf bank_mask:0xf
    v_fma_f32 v205, v180, v200, v41
    v_fma_f32 v206, v184, v201, v49
    v_fma_f32 v207, v188, v202, v57
    v_fma_f32 v208, v192, v203, v65
    v_fma_f32 v209, v196, v204, v73
    v_fmac_f32_dpp v205, v200, v181 row_ror:8 row_mask:0xf bank_mask:0xf
    v_fmac_f32_dpp v206, v201, v185 row_ror:8 row_mask:0xf bank_mask:0xf
    v_fmac_f32_dpp v207, v202, v189 row_ror:8 row_mask:0xf bank_mask:0xf
    v_fmac_f32_dpp v208, v203, v193 row_ror:8 row_mask:0xf bank_mask:0xf
    v_fmac_f32_dpp v209, v204, v197 row_ror:8 row_mask:0xf bank_mask:0xf
    v_fma_f32 v200, v180, v205, v42
    v_fma_f32 v201, v184, v206, v50
    v_fma_f32 v202, v188, v207, v58
    v_fma_f32 v203, v192, v208, v66
    v_fma_f32 v204, v196, v209, v74
    v_fmac_f32_dpp v200, v205, v181 row_ror:8 row_mask:0xf bank_mask:0xf
    v_fmac_f32_dpp v201, v206, v185 row_ror:8 row_mask:0xf bank_mask:0xf
    v_fmac_f32_dpp v202, v207, v189 row_ror:8 row_mask:0xf bank_mask:0xf
    v_fmac_f32_dpp v203, v208, v193 row_ror:8 row_mask:0xf bank_mask:0xf
    v_fmac_f32_dpp v204, v209, v197 row_ror:8 row_mask:0xf bank_mask:0xf
    v_fma_f32 v205, v180, v200, v43
    v_fma_f32 v206, v184, v201, v51
    v_fma_f32 v207, v188, v202, v59
    v_fma_f32 v208, v192, v203, v67
    v_fma_f32 v209, v196, v204, v75
    v_fmac_f32_dpp v205, v200, v181 row_ror:8 row_mask:0xf bank_mask:0xf
    v_fmac_f32_dpp v206, v201, v185 row_ror:8 row_mask:0xf bank_mask:0xf
    v_fmac_f32_dpp v207, v202, v189 row_ror:8 row_mask:0xf bank_mask:0xf
    v_fmac_f32_dpp v208, v203, v193 row_ror:8 row_mask:0xf bank_mask:0xf
    v_fmac_f32_dpp v209, v204, v197 row_ror:8 row_mask:0xf bank_mask:0xf
    ds_write_b32 v239, v205 offset:0
    ds_write_b32 v239, v206 offset:64
    ds_write_b32 v239, v207 offset:128
    ds_write_b32 v239, v208 offset:192
    ds_write_b32 v239, v209 offset:256
    s_waitcnt vmcnt(3) lgkmcnt(0)
    s_barrier
    ds_read_b64_tr_b16 a[160:161], v144 offset:4096
    ds_read_b64_tr_b16 a[162:163], v144 offset:4864
    ds_read_b64_tr_b16 a[164:165], v145 offset:4096
    ds_read_b64_tr_b16 a[166:167], v145 offset:4864
    ds_read_b64_tr_b16 a[168:169], v144 offset:4160
    ds_read_b64_tr_b16 a[170:171], v144 offset:4928
    ds_read_b64_tr_b16 a[172:173], v145 offset:4160
    ds_read_b64_tr_b16 a[174:175], v145 offset:4928
    ds_read_b64_tr_b16 a[176:177], v144 offset:4224
    ds_read_b64_tr_b16 a[178:179], v144 offset:4992
    ds_read_b64_tr_b16 a[180:181], v145 offset:4224
    ds_read_b64_tr_b16 a[182:183], v145 offset:4992
    s_cmp_lg_u32 s27, 0
    s_cbranch_scc1 L_nopub
    ds_read2_b32 v[200:201], v244 offset0:0 offset1:8
    ds_read2_b32 v[202:203], v244 offset0:80 offset1:88
    ds_read2_b32 v[204:205], v244 offset0:160 offset1:168
    ds_read2_b32 v[206:207], v244 offset0:240 offset1:248
    ds_read2_b32 v[208:209], v245 offset0:0 offset1:8
    ds_read2_b32 v[210:211], v245 offset0:80 offset1:88
    ds_read2_b32 v[212:213], v245 offset0:160 offset1:168
    ds_read2_b32 v[214:215], v245 offset0:240 offset1:248
    ds_read2_b32 v[216:217], v246 offset0:0 offset1:8
    ds_read2_b32 v[218:219], v246 offset0:80 offset1:88
    ds_read2_b32 v[220:221], v246 offset0:160 offset1:168
    ds_read2_b32 v[222:223], v246 offset0:240 offset1:248
    ds_read2_b32 v[224:225], v247 offset0:0 offset1:8
    ds_read2_b32 v[226:227], v247 offset0:80 offset1:88
    ds_read2_b32 v[228:229], v247 offset0:160 offset1:168
    ds_read2_b32 v[230:231], v247 offset0:240 offset1:248
    s_waitcnt lgkmcnt(8)
    s_nop 0
    v_pk_fma_f32 v[232:233], v[26:27], v[200:201], v[202:203] op_sel_hi:[0,1,1]
    v_pk_fma_f32 v[232:233], v[26:27], v[200:201], v[232:233] op_sel:[1,1,0] op_sel_hi:[1,0,1] neg_lo:[0,1,0]
    v_pk_fma_f32 v[234:235], v[26:27], v[232:233], v[204:205] op_sel_hi:[0,1,1]
    v_pk_fma_f32 v[234:235], v[26:27], v[232:233], v[234:235] op_sel:[1,1,0] op_sel_hi:[1,0,1] neg_lo:[0,1,0]
    v_pk_fma_f32 v[232:233], v[26:27], v[234:235], v[206:207] op_sel_hi:[0,1,1]
    v_pk_fma_f32 v[232:233], v[26:27], v[234:235], v[232:233] op_sel:[1,1,0] op_sel_hi:[1,0,1] neg_lo:[0,1,0]
    v_pk_fma_f32 v[234:235], v[26:27], v[232:233], v[208:209] op_sel_hi:[0,1,1]
    v_pk_fma_f32 v[234:235], v[26:27], v[232:233], v[234:235] op_sel:[1,1,0] op_sel_hi:[1,0,1] neg_lo:[0,1,0]
    v_pk_fma_f32 v[232:233], v[26:27], v[234:235], v[210:211] op_sel_hi:[0,1,1]
    v_pk_fma_f32 v[232:233], v[26:27], v[234:235], v[232:233] op_sel:[1,1,0] op_sel_hi:[1,0,1] neg_lo:[0,1,0]
    v_pk_fma_f32 v[234:235], v[26:27], v[232:233], v[212:213] op_sel_hi:[0,1,1]
    v_pk_fma_f32 v[234:235], v[26:27], v[232:233], v[234:235] op_sel:[1,1,0] op_sel_hi:[1,0,1] neg_lo:[0,1,0]
    v_pk_fma_f32 v[232:233], v[26:27], v[234:235], v[214:215] op_sel_hi:[0,1,1]
    v_pk_fma_f32 v[232:233], v[26:27], v[234:235], v[232:233] op_sel:[1,1,0] op_sel_hi:[1,0,1] neg_lo:[0,1,0]
    s_waitcnt lgkmcnt(4)
    s_nop 0
    v_pk_fma_f32 v[234:235], v[26:27], v[232:233], v[216:217] op_sel_hi:[0,1,1]
    v_pk_fma_f32 v[234:235], v[26:27], v[232:233], v[234:235] op_sel:[1,1,0] op_sel_hi:[1,0,1] neg_lo:[0,1,0]
    v_pk_fma_f32 v[232:233], v[26:27], v[234:235], v[218:219] op_sel_hi:[0,1,1]
    v_pk_fma_f32 v[232:233], v[26:27], v[234:235], v[232:233] op_sel:[1,1,0] op_sel_hi:[1,0,1] neg_lo:[0,1,0]
    v_pk_fma_f32 v[234:235], v[26:27], v[232:233], v[220:221] op_sel_hi:[0,1,1]
    v_pk_fma_f32 v[234:235], v[26:27], v[232:233], v[234:235] op_sel:[1,1,0] op_sel_hi:[1,0,1] neg_lo:[0,1,0]
    v_pk_fma_f32 v[232:233], v[26:27], v[234:235], v[222:223] op_sel_hi:[0,1,1]
    v_pk_fma_f32 v[232:233], v[26:27], v[234:235], v[232:233] op_sel:[1,1,0] op_sel_hi:[1,0,1] neg_lo:[0,1,0]
    s_waitcnt lgkmcnt(0)
    s_nop 0
    v_pk_fma_f32 v[234:235], v[26:27], v[232:233], v[224:225] op_sel_hi:[0,1,1]
    v_pk_fma_f32 v[234:235], v[26:27], v[232:233], v[234:235] op_sel:[1,1,0] op_sel_hi:[1,0,1] neg_lo:[0,1,0]
    v_pk_fma_f32 v[232:233], v[26:27], v[234:235], v[226:227] op_sel_hi:[0,1,1]
    v_pk_fma_f32 v[232:233], v[26:27], v[234:235], v[232:233] op_sel:[1,1,0] op_sel_hi:[1,0,1] neg_lo:[0,1,0]
    v_pk_fma_f32 v[234:235], v[26:27], v[232:233], v[228:229] op_sel_hi:[0,1,1]
    v_pk_fma_f32 v[234:235], v[26:27], v[232:233], v[234:235] op_sel:[1,1,0] op_sel_hi:[1,0,1] neg_lo:[0,1,0]
    v_pk_fma_f32 v[232:233], v[26:27], v[234:235], v[230:231] op_sel_hi:[0,1,1]
    v_pk_fma_f32 v[232:233], v[26:27], v[234:235], v[232:233] op_sel:[1,1,0] op_sel_hi:[1,0,1] neg_lo:[0,1,0]
    v_cmp_eq_u32 vcc, -1, v232
    s_nop 1
    v_cndmask_b32_e64 v232, v232, v1, vcc
    buffer_store_dwordx2 v[232:233], v236, s[8:11], 0 offen sc1
    s_branch L_pub_end
L_nopub:
L_pub_end:
    s_waitcnt lgkmcnt(8)
    v_mfma_f32_16x16x32_bf16 v[76:79], a[160:163], a[0:3], 0
    ds_read_b64_tr_b16 a[184:185], v144 offset:10240
    s_add_u32 s23, s23, 128
    s_cmp_eq_u32 s23, 1280
    s_cselect_b32 s23, 0, s23
    s_add_u32 m0, s22, 135168
    s_mul_i32 s21, s23, 1536
    s_lshl_b32 s32, s28, 4
    s_add_u32 s33, s32, s29
    v_mfma_f32_16x16x32_bf16 v[80:83], a[160:163], a[4:7], 0
    ds_read_b64_tr_b16 a[186:187], v144 offset:11008
    buffer_load_dwordx4 v14, s[16:19], s21 offen offset:0 lds
    s_xor_b32 s32, s33, 8
    v_mfma_f32_16x16x32_bf16 v[84:87], a[164:167], a[0:3], 0
    ds_read_b64_tr_b16 a[188:189], v145 offset:10240
    s_mul_i32 s33, s33, 12288
    v_mfma_f32_16x16x32_bf16 v[88:91], a[164:167], a[4:7], 0
    ds_read_b64_tr_b16 a[190:191], v145 offset:11008
    s_mul_i32 s32, s32, 12288
    s_waitcnt lgkmcnt(8)
    v_mfma_f32_16x16x32_bf16 v[92:95], a[168:171], a[0:3], 0
    ds_read_b64_tr_b16 a[192:193], v144 offset:10304
    buffer_load_dwordx4 v15, s[16:19], s21 offen offset:1024 lds
    s_mul_i32 s35, s27, 3072
    v_mfma_f32_16x16x32_bf16 v[96:99], a[168:171], a[4:7], 0
    ds_read_b64_tr_b16 a[194:195], v144 offset:11072
    s_add_u32 s35, s35, 27262976
    v_mfma_f32_16x16x32_bf16 v[100:103], a[172:175], a[0:3], 0
    ds_read_b64_tr_b16 a[196:197], v145 offset:10304
    s_add_u32 s77, s33, s35
    s_add_u32 s75, s32, s35
    v_mfma_f32_16x16x32_bf16 v[104:107], a[172:175], a[4:7], 0
    ds_read_b64_tr_b16 a[198:199], v145 offset:11072
    v_mov_b32 v152, -1
    s_waitcnt lgkmcnt(8)
    v_mfma_f32_16x16x32_bf16 v[108:111], a[176:179], a[0:3], 0
    ds_read_b64_tr_b16 a[200:201], v144 offset:10368
    buffer_load_dwordx4 v16, s[16:19], s21 offen offset:2048 lds
    v_mov_b32 v153, -1
    v_mfma_f32_16x16x32_bf16 v[112:115], a[176:179], a[4:7], 0
    ds_read_b64_tr_b16 a[202:203], v144 offset:11136
    v_mov_b32_e64 v154, -1
    v_mfma_f32_16x16x32_bf16 v[116:119], a[180:183], a[0:3], 0
    ds_read_b64_tr_b16 a[204:205], v145 offset:10368
    v_mov_b32_e64 v155, -1
    v_mfma_f32_16x16x32_bf16 v[120:123], a[180:183], a[4:7], 0
    ds_read_b64_tr_b16 a[206:207], v145 offset:11136
    v_lshlrev_b32 v9, 3, v2
    s_waitcnt lgkmcnt(8)
    v_mfma_f32_16x16x32_bf16 v[76:79], a[184:187], a[8:11], v[76:79]
    ds_read_b64_tr_b16 a[160:161], v144 offset:16384
    s_add_u32 s23, s23, 128
    s_cmp_eq_u32 s23, 1280
    s_cselect_b32 s23, 0, s23
    s_add_u32 m0, s22, 28672
    s_mul_i32 s21, s23, 1536
    v_mfma_f32_16x16x32_bf16 v[80:83], a[184:187], a[12:15], v[80:83]
    ds_read_b64_tr_b16 a[162:163], v144 offset:17152
    buffer_load_dwordx4 v14, s[16:19], s21 offen offset:0 lds
    v_mfma_f32_16x16x32_bf16 v[84:87], a[188:191], a[8:11], v[84:87]
    ds_read_b64_tr_b16 a[164:165], v145 offset:16384
    v_mfma_f32_16x16x32_bf16 v[88:91], a[188:191], a[12:15], v[88:91]
    ds_read_b64_tr_b16 a[166:167], v145 offset:17152
    buffer_load_dwordx4 v15, s[16:19], s21 offen offset:1024 lds
    s_waitcnt lgkmcnt(8)
    v_mfma_f32_16x16x32_bf16 v[92:95], a[192:195], a[8:11], v[92:95]
    ds_read_b64_tr_b16 a[168:169], v144 offset:16448
    v_mfma_f32_16x16x32_bf16 v[96:99], a[192:195], a[12:15], v[96:99]
    ds_read_b64_tr_b16 a[170:171], v144 offset:17216
    v_mfma_f32_16x16x32_bf16 v[100:103], a[196:199], a[8:11], v[100:103]
    ds_read_b64_tr_b16 a[172:173], v145 offset:16448
    buffer_load_dwordx4 v16, s[16:19], s21 offen offset:2048 lds
    v_mfma_f32_16x16x32_bf16 v[104:107], a[196:199], a[12:15], v[104:107]
    ds_read_b64_tr_b16 a[174:175], v145 offset:17216
    s_waitcnt lgkmcnt(8)
    v_mfma_f32_16x16x32_bf16 v[108:111], a[200:203], a[8:11], v[108:111]
    ds_read_b64_tr_b16 a[176:177], v144 offset:16512
    v_mfma_f32_16x16x32_bf16 v[112:115], a[200:203], a[12:15], v[112:115]
    ds_read_b64_tr_b16 a[178:179], v144 offset:17280
    buffer_store_dwordx4 v[152:155], v34, s[12:15], s77 offen offset:0 sc1
    v_mfma_f32_16x16x32_bf16 v[116:119], a[204:207], a[8:11], v[116:119]
    ds_read_b64_tr_b16 a[180:181], v145 offset:16512
    v_mfma_f32_16x16x32_bf16 v[120:123], a[204:207], a[12:15], v[120:123]
    ds_read_b64_tr_b16 a[182:183], v145 offset:17280
    s_waitcnt lgkmcnt(8)
    v_mfma_f32_16x16x32_bf16 v[76:79], a[160:163], a[16:19], v[76:79]
    ds_read_b64_tr_b16 a[184:185], v144 offset:22528
    s_add_u32 s23, s23, 128
    s_cmp_eq_u32 s23, 1280
    s_cselect_b32 s23, 0, s23
    s_add_u32 m0, s22, 40960
    s_mul_i32 s21, s23, 1536
    v_mfma_f32_16x16x32_bf16 v[80:83], a[160:163], a[20:23], v[80:83]
    ds_read_b64_tr_b16 a[186:187], v144 offset:23296
    buffer_load_dwordx4 v14, s[16:19], s21 offen offset:0 lds
    v_mfma_f32_16x16x32_bf16 v[84:87], a[164:167], a[16:19], v[84:87]
    ds_read_b64_tr_b16 a[188:189], v145 offset:22528
    v_mfma_f32_16x16x32_bf16 v[88:91], a[164:167], a[20:23], v[88:91]
    ds_read_b64_tr_b16 a[190:191], v145 offset:23296
    buffer_load_dwordx4 v15, s[16:19], s21 offen offset:1024 lds
    s_waitcnt lgkmcnt(8)
    v_mfma_f32_16x16x32_bf16 v[92:95], a[168:171], a[16:19], v[92:95]
    ds_read_b64_tr_b16 a[192:193], v144 offset:22592
    v_mfma_f32_16x16x32_bf16 v[96:99], a[168:171], a[20:23], v[96:99]
    ds_read_b64_tr_b16 a[194:195], v144 offset:23360
    v_mfma_f32_16x16x32_bf16 v[100:103], a[172:175], a[16:19], v[100:103]
    ds_read_b64_tr_b16 a[196:197], v145 offset:22592
    buffer_load_dwordx4 v16, s[16:19], s21 offen offset:2048 lds
    v_mfma_f32_16x16x32_bf16 v[104:107], a[172:175], a[20:23], v[104:107]
    ds_read_b64_tr_b16 a[198:199], v145 offset:23360
    s_waitcnt lgkmcnt(8)
    v_mfma_f32_16x16x32_bf16 v[108:111], a[176:179], a[16:19], v[108:111]
    ds_read_b64_tr_b16 a[200:201], v144 offset:22656
    v_mfma_f32_16x16x32_bf16 v[112:115], a[176:179], a[20:23], v[112:115]
    ds_read_b64_tr_b16 a[202:203], v144 offset:23424
    buffer_store_dwordx4 v[152:155], v34, s[12:15], s77 offen offset:1024 sc1
    v_mfma_f32_16x16x32_bf16 v[116:119], a[180:183], a[16:19], v[116:119]
    ds_read_b64_tr_b16 a[204:205], v145 offset:22656
    v_mfma_f32_16x16x32_bf16 v[120:123], a[180:183], a[20:23], v[120:123]
    ds_read_b64_tr_b16 a[206:207], v145 offset:23424
    s_waitcnt lgkmcnt(8)
    v_mfma_f32_16x16x32_bf16 v[76:79], a[184:187], a[24:27], v[76:79]
    ds_read_b64_tr_b16 a[160:161], v144 offset:28672
    s_add_u32 s23, s23, 128
    s_cmp_eq_u32 s23, 1280
    s_cselect_b32 s23, 0, s23
    s_add_u32 m0, s22, 57344
    s_mul_i32 s21, s23, 1536
    v_mfma_f32_16x16x32_bf16 v[80:83], a[184:187], a[28:31], v[80:83]
    ds_read_b64_tr_b16 a[162:163], v144 offset:29440
    buffer_load_dwordx4 v14, s[16:19], s21 offen offset:0 lds
    v_mfma_f32_16x16x32_bf16 v[84:87], a[188:191], a[24:27], v[84:87]
    ds_read_b64_tr_b16 a[164:165], v145 offset:28672
    v_mfma_f32_16x16x32_bf16 v[88:91], a[188:191], a[28:31], v[88:91]
    ds_read_b64_tr_b16 a[166:167], v145 offset:29440
    buffer_load_dwordx4 v15, s[16:19], s21 offen offset:1024 lds
    s_waitcnt lgkmcnt(8)
    v_mfma_f32_16x16x32_bf16 v[92:95], a[192:195], a[24:27], v[92:95]
    ds_read_b64_tr_b16 a[168:169], v144 offset:28736
    v_mfma_f32_16x16x32_bf16 v[96:99], a[192:195], a[28:31], v[96:99]
    ds_read_b64_tr_b16 a[170:171], v144 offset:29504
    v_mfma_f32_16x16x32_bf16 v[100:103], a[196:199], a[24:27], v[100:103]
    ds_read_b64_tr_b16 a[172:173], v145 offset:28736
    buffer_load_dwordx4 v16, s[16:19], s21 offen offset:2048 lds
    v_mfma_f32_16x16x32_bf16 v[104:107], a[196:199], a[28:31], v[104:107]
    ds_read_b64_tr_b16 a[174:175], v145 offset:29504
    s_waitcnt lgkmcnt(8)
    v_mfma_f32_16x16x32_bf16 v[108:111], a[200:203], a[24:27], v[108:111]
    ds_read_b64_tr_b16 a[176:177], v144 offset:28800
    v_mfma_f32_16x16x32_bf16 v[112:115], a[200:203], a[28:31], v[112:115]
    ds_read_b64_tr_b16 a[178:179], v144 offset:29568
    buffer_store_dwordx2 v[152:153], v9, s[12:15], s77 offen offset:2048 sc1
    v_mfma_f32_16x16x32_bf16 v[116:119], a[204:207], a[24:27], v[116:119]
    ds_read_b64_tr_b16 a[180:181], v145 offset:28800
    v_mfma_f32_16x16x32_bf16 v[120:123], a[204:207], a[28:31], v[120:123]
    ds_read_b64_tr_b16 a[182:183], v145 offset:29568
    s_waitcnt lgkmcnt(8)
    v_mfma_f32_16x16x32_bf16 v[76:79], a[160:163], a[32:35], v[76:79]
    ds_read_b64_tr_b16 a[184:185], v144 offset:34816
    s_add_u32 s23, s23, 128
    s_cmp_eq_u32 s23, 1280
    s_cselect_b32 s23, 0, s23
    s_add_u32 m0, s22, 0
    s_mul_i32 s21, s23, 1536
    v_mfma_f32_16x16x32_bf16 v[80:83], a[160:163], a[36:39], v[80:83]
    ds_read_b64_tr_b16 a[186:187], v144 offset:35584
    buffer_load_dwordx4 v14, s[16:19], s21 offen offset:0 lds
    v_mfma_f32_16x16x32_bf16 v[84:87], a[164:167], a[32:35], v[84:87]
    ds_read_b64_tr_b16 a[188:189], v145 offset:34816
    v_mfma_f32_16x16x32_bf16 v[88:91], a[164:167], a[36:39], v[88:91]
    ds_read_b64_tr_b16 a[190:191], v145 offset:35584
    s_waitcnt lgkmcnt(8)
    v_mfma_f32_16x16x32_bf16 v[92:95], a[168:171], a[32:35], v[92:95]
    ds_read_b64_tr_b16 a[192:193], v144 offset:34880
    buffer_load_dwordx4 v15, s[16:19], s21 offen offset:1024 lds
    v_mfma_f32_16x16x32_bf16 v[96:99], a[168:171], a[36:39], v[96:99]
    ds_read_b64_tr_b16 a[194:195], v144 offset:35648
    v_mfma_f32_16x16x32_bf16 v[100:103], a[172:175], a[32:35], v[100:103]
    ds_read_b64_tr_b16 a[196:197], v145 offset:34880
    v_mfma_f32_16x16x32_bf16 v[104:107], a[172:175], a[36:39], v[104:107]
    ds_read_b64_tr_b16 a[198:199], v145 offset:35648
    s_waitcnt lgkmcnt(8)
    v_mfma_f32_16x16x32_bf16 v[108:111], a[176:179], a[32:35], v[108:111]
    ds_read_b64_tr_b16 a[200:201], v144 offset:34944
    buffer_load_dwordx4 v16, s[16:19], s21 offen offset:2048 lds
    v_mfma_f32_16x16x32_bf16 v[112:115], a[176:179], a[36:39], v[112:115]
    ds_read_b64_tr_b16 a[202:203], v144 offset:35712
    v_mfma_f32_16x16x32_bf16 v[116:119], a[180:183], a[32:35], v[116:119]
    ds_read_b64_tr_b16 a[204:205], v145 offset:34944
    v_mfma_f32_16x16x32_bf16 v[120:123], a[180:183], a[36:39], v[120:123]
    ds_read_b64_tr_b16 a[206:207], v145 offset:35712
    s_waitcnt vmcnt(15)
    s_barrier
    s_waitcnt lgkmcnt(8)
    v_mfma_f32_16x16x32_bf16 v[76:79], a[184:187], a[40:43], v[76:79]
    ds_read_b64_tr_b16 a[160:161], v144 offset:40960
    s_add_u32 s23, s23, 128
    s_cmp_eq_u32 s23, 1280
    s_cselect_b32 s23, 0, s23
    s_add_u32 m0, s22, 12288
    s_mul_i32 s21, s23, 1536
    v_mfma_f32_16x16x32_bf16 v[80:83], a[184:187], a[44:47], v[80:83]
    ds_read_b64_tr_b16 a[162:163], v144 offset:41728
    buffer_load_dwordx4 v14, s[16:19], s21 offen offset:0 lds
    v_mfma_f32_16x16x32_bf16 v[84:87], a[188:191], a[40:43], v[84:87]
    ds_read_b64_tr_b16 a[164:165], v145 offset:40960
    v_mfma_f32_16x16x32_bf16 v[88:91], a[188:191], a[44:47], v[88:91]
    ds_read_b64_tr_b16 a[166:167], v145 offset:41728
    s_waitcnt lgkmcnt(8)
    v_mfma_f32_16x16x32_bf16 v[92:95], a[192:195], a[40:43], v[92:95]
    ds_read_b64_tr_b16 a[168:169], v144 offset:41024
    buffer_load_dwordx4 v15, s[16:19], s21 offen offset:1024 lds
    v_mfma_f32_16x16x32_bf16 v[96:99], a[192:195], a[44:47], v[96:99]
    ds_read_b64_tr_b16 a[170:171], v144 offset:41792
    v_mfma_f32_16x16x32_bf16 v[100:103], a[196:199], a[40:43], v[100:103]
    ds_read_b64_tr_b16 a[172:173], v145 offset:41024
    v_mfma_f32_16x16x32_bf16 v[104:107], a[196:199], a[44:47], v[104:107]
    ds_read_b64_tr_b16 a[174:175], v145 offset:41792
    s_waitcnt lgkmcnt(8)
    v_mfma_f32_16x16x32_bf16 v[108:111], a[200:203], a[40:43], v[108:111]
    ds_read_b64_tr_b16 a[176:177], v144 offset:41088
    buffer_load_dwordx4 v16, s[16:19], s21 offen offset:2048 lds
    v_mfma_f32_16x16x32_bf16 v[112:115], a[200:203], a[44:47], v[112:115]
    ds_read_b64_tr_b16 a[178:179], v144 offset:41856
    v_mfma_f32_16x16x32_bf16 v[116:119], a[204:207], a[40:43], v[116:119]
    ds_read_b64_tr_b16 a[180:181], v145 offset:41088
    v_mfma_f32_16x16x32_bf16 v[120:123], a[204:207], a[44:47], v[120:123]
    ds_read_b64_tr_b16 a[182:183], v145 offset:41856
    s_cmp_lg_u32 s27, 0
    s_cbranch_scc1 L_nolbld
    buffer_load_dwordx2 v[200:201], v237, s[8:11], 0 offen offset:0 sc1
    buffer_load_dwordx2 v[202:203], v237, s[8:11], 0 offen offset:320 sc1
    buffer_load_dwordx2 v[204:205], v237, s[8:11], 0 offen offset:640 sc1
    buffer_load_dwordx2 v[206:207], v237, s[8:11], 0 offen offset:960 sc1
    buffer_load_dwordx2 v[208:209], v237, s[8:11], 0 offen offset:1280 sc1
    buffer_load_dwordx2 v[210:211], v237, s[8:11], 0 offen offset:1600 sc1
    buffer_load_dwordx2 v[212:213], v237, s[8:11], 0 offen offset:1920 sc1
    buffer_load_dwordx2 v[214:215], v237, s[8:11], 0 offen offset:2240 sc1
    buffer_load_dwordx2 v[216:217], v237, s[8:11], 0 offen offset:2560 sc1
    buffer_load_dwordx2 v[218:219], v237, s[8:11], 0 offen offset:2880 sc1
    buffer_load_dwordx2 v[220:221], v237, s[8:11], 0 offen offset:3200 sc1
    buffer_load_dwordx2 v[222:223], v237, s[8:11], 0 offen offset:3520 sc1
    buffer_load_dwordx2 v[224:225], v237, s[8:11], 0 offen offset:3840 sc1
    buffer_load_dwordx2 v[226:227], v238, s[8:11], 0 offen offset:0 sc1
    buffer_load_dwordx2 v[228:229], v238, s[8:11], 0 offen offset:320 sc1
L_nolbld:
    s_waitcnt lgkmcnt(8)
    v_mfma_f32_16x16x32_bf16 v[76:79], a[160:163], a[48:51], v[76:79]
    ds_read_b64_tr_b16 a[184:185], v144 offset:47104
    s_add_u32 s66, s70, 0
    v_mfma_f32_16x16x32_bf16 v[80:83], a[160:163], a[52:55], v[80:83]
    ds_read_b64_tr_b16 a[186:187], v144 offset:47872
    buffer_load_dwordx4 a[236:239], v34, s[12:15], s66 offen offset:0 sc1
    v_mfma_f32_16x16x32_bf16 v[84:87], a[164:167], a[48:51], v[84:87]
    ds_read_b64_tr_b16 a[188:189], v145 offset:47104
    v_mfma_f32_16x16x32_bf16 v[88:91], a[164:167], a[52:55], v[88:91]
    ds_read_b64_tr_b16 a[190:191], v145 offset:47872
    s_waitcnt lgkmcnt(8)
    v_mfma_f32_16x16x32_bf16 v[92:95], a[168:171], a[48:51], v[92:95]
    ds_read_b64_tr_b16 a[192:193], v144 offset:47168
    buffer_load_dwordx4 a[240:243], v34, s[12:15], s66 offen offset:1024 sc1
    v_mfma_f32_16x16x32_bf16 v[96:99], a[168:171], a[52:55], v[96:99]
    ds_read_b64_tr_b16 a[194:195], v144 offset:47936
    v_mfma_f32_16x16x32_bf16 v[100:103], a[172:175], a[48:51], v[100:103]
    ds_read_b64_tr_b16 a[196:197], v145 offset:47168
    v_mfma_f32_16x16x32_bf16 v[104:107], a[172:175], a[52:55], v[104:107]
    ds_read_b64_tr_b16 a[198:199], v145 offset:47936
    s_waitcnt lgkmcnt(8)
    v_mfma_f32_16x16x32_bf16 v[108:111], a[176:179], a[48:51], v[108:111]
    ds_read_b64_tr_b16 a[200:201], v144 offset:47232
    buffer_load_dwordx4 a[244:247], v34, s[12:15], s66 offen offset:2048 sc1
    v_mfma_f32_16x16x32_bf16 v[112:115], a[176:179], a[52:55], v[112:115]
    ds_read_b64_tr_b16 a[202:203], v144 offset:48000
    v_mfma_f32_16x16x32_bf16 v[116:119], a[180:183], a[48:51], v[116:119]
    ds_read_b64_tr_b16 a[204:205], v145 offset:47232
    v_mfma_f32_16x16x32_bf16 v[120:123], a[180:183], a[52:55], v[120:123]
    ds_read_b64_tr_b16 a[206:207], v145 offset:48000
    s_waitcnt lgkmcnt(8)
    v_mfma_f32_16x16x32_bf16 v[76:79], a[184:187], a[56:59], v[76:79]
    ds_read_b64_tr_b16 a[160:161], v144 offset:53248
    v_mfma_f32_16x16x32_bf16 v[80:83], a[184:187], a[60:63], v[80:83]
    ds_read_b64_tr_b16 a[162:163], v144 offset:54016
    buffer_load_dwordx4 a[248:251], v34, s[12:15], s66 offen offset:3072 sc1
    v_mfma_f32_16x16x32_bf16 v[84:87], a[188:191], a[56:59], v[84:87]
    ds_read_b64_tr_b16 a[164:165], v145 offset:53248
    v_mfma_f32_16x16x32_bf16 v[88:91], a[188:191], a[60:63], v[88:91]
    ds_read_b64_tr_b16 a[166:167], v145 offset:54016
    s_waitcnt lgkmcnt(8)
    v_mfma_f32_16x16x32_bf16 v[92:95], a[192:195], a[56:59], v[92:95]
    ds_read_b64_tr_b16 a[168:169], v144 offset:53312
    buffer_load_dwordx4 a[252:255], v35, s[12:15], s66 offen offset:0 sc1
    v_mfma_f32_16x16x32_bf16 v[96:99], a[192:195], a[60:63], v[96:99]
    ds_read_b64_tr_b16 a[170:171], v144 offset:54080
    v_mfma_f32_16x16x32_bf16 v[100:103], a[196:199], a[56:59], v[100:103]
    ds_read_b64_tr_b16 a[172:173], v145 offset:53312
    v_mfma_f32_16x16x32_bf16 v[104:107], a[196:199], a[60:63], v[104:107]
    ds_read_b64_tr_b16 a[174:175], v145 offset:54080
    s_add_u32 s66, s70, 5120
    s_waitcnt lgkmcnt(8)
    v_mfma_f32_16x16x32_bf16 v[108:111], a[200:203], a[56:59], v[108:111]
    ds_read_b64_tr_b16 a[176:177], v144 offset:53376
    buffer_load_dwordx4 a[0:3], v34, s[12:15], s66 offen offset:0 sc1
    v_mfma_f32_16x16x32_bf16 v[112:115], a[200:203], a[60:63], v[112:115]
    ds_read_b64_tr_b16 a[178:179], v144 offset:54144
    v_mfma_f32_16x16x32_bf16 v[116:119], a[204:207], a[56:59], v[116:119]
    ds_read_b64_tr_b16 a[180:181], v145 offset:53376
    v_mfma_f32_16x16x32_bf16 v[120:123], a[204:207], a[60:63], v[120:123]
    ds_read_b64_tr_b16 a[182:183], v145 offset:54144
    s_waitcnt vmcnt(6)
    s_barrier
    s_cmp_lg_u32 s27, 0
    s_cbranch_scc1 L_nolb
    s_waitcnt vmcnt(6)
    s_mov_b32 s32, 0
L_lb:
    v_max_u32 v1, v200, v202
    v_max3_u32 v1, v1, v204, v206
    v_max3_u32 v1, v1, v208, v210
    v_max3_u32 v1, v1, v212, v214
    v_max3_u32 v1, v1, v216, v218
    v_max3_u32 v1, v1, v220, v222
    v_max3_u32 v1, v1, v224, v226
    v_max3_u32 v1, v1, v228, v228
    v_cmp_eq_u32 vcc, -1, v1
    s_add_u32 s32, s32, 1
    s_cmp_eq_u64 vcc, 0
    s_cbranch_scc1 L_lbd
    s_cmp_gt_u32 s32, 200000
    s_cbranch_scc1 L_lbd
    s_nop 0
    buffer_load_dwordx2 v[200:201], v237, s[8:11], 0 offen offset:0 sc1
    buffer_load_dwordx2 v[202:203], v237, s[8:11], 0 offen offset:320 sc1
    buffer_load_dwordx2 v[204:205], v237, s[8:11], 0 offen offset:640 sc1
    buffer_load_dwordx2 v[206:207], v237, s[8:11], 0 offen offset:960 sc1
    buffer_load_dwordx2 v[208:209], v237, s[8:11], 0 offen offset:1280 sc1
    buffer_load_dwordx2 v[210:211], v237, s[8:11], 0 offen offset:1600 sc1
    buffer_load_dwordx2 v[212:213], v237, s[8:11], 0 offen offset:1920 sc1
    buffer_load_dwordx2 v[214:215], v237, s[8:11], 0 offen offset:2240 sc1
    buffer_load_dwordx2 v[216:217], v237, s[8:11], 0 offen offset:2560 sc1
    buffer_load_dwordx2 v[218:219], v237, s[8:11], 0 offen offset:2880 sc1
    buffer_load_dwordx2 v[220:221], v237, s[8:11], 0 offen offset:3200 sc1
    buffer_load_dwordx2 v[222:223], v237, s[8:11], 0 offen offset:3520 sc1
    buffer_load_dwordx2 v[224:225], v237, s[8:11], 0 offen offset:3840 sc1
    buffer_load_dwordx2 v[226:227], v238, s[8:11], 0 offen offset:0 sc1
    buffer_load_dwordx2 v[228:229], v238, s[8:11], 0 offen offset:320 sc1
    s_waitcnt vmcnt(0)
    s_branch L_lb
L_lbd:
    v_pk_fma_f32 v[232:233], v[28:29], v[228:229], v[226:227] op_sel_hi:[0,1,1]
    v_pk_fma_f32 v[232:233], v[28:29], v[228:229], v[232:233] op_sel:[1,1,0] op_sel_hi:[1,0,1] neg_lo:[0,1,0]
    v_pk_fma_f32 v[234:235], v[28:29], v[232:233], v[224:225] op_sel_hi:[0,1,1]
    v_pk_fma_f32 v[234:235], v[28:29], v[232:233], v[234:235] op_sel:[1,1,0] op_sel_hi:[1,0,1] neg_lo:[0,1,0]
    v_pk_fma_f32 v[232:233], v[28:29], v[234:235], v[222:223] op_sel_hi:[0,1,1]
    v_pk_fma_f32 v[232:233], v[28:29], v[234:235], v[232:233] op_sel:[1,1,0] op_sel_hi:[1,0,1] neg_lo:[0,1,0]
    v_pk_fma_f32 v[234:235], v[28:29], v[232:233], v[220:221] op_sel_hi:[0,1,1]
    v_pk_fma_f32 v[234:235], v[28:29], v[232:233], v[234:235] op_sel:[1,1,0] op_sel_hi:[1,0,1] neg_lo:[0,1,0]
    v_pk_fma_f32 v[232:233], v[28:29], v[234:235], v[218:219] op_sel_hi:[0,1,1]
    v_pk_fma_f32 v[232:233], v[28:29], v[234:235], v[232:233] op_sel:[1,1,0] op_sel_hi:[1,0,1] neg_lo:[0,1,0]
    v_pk_fma_f32 v[234:235], v[28:29], v[232:233], v[216:217] op_sel_hi:[0,1,1]
    v_pk_fma_f32 v[234:235], v[28:29], v[232:233], v[234:235] op_sel:[1,1,0] op_sel_hi:[1,0,1] neg_lo:[0,1,0]
    v_pk_fma_f32 v[232:233], v[28:29], v[234:235], v[214:215] op_sel_hi:[0,1,1]
    v_pk_fma_f32 v[232:233], v[28:29], v[234:235], v[232:233] op_sel:[1,1,0] op_sel_hi:[1,0,1] neg_lo:[0,1,0]
    v_pk_fma_f32 v[234:235], v[28:29], v[232:233], v[212:213] op_sel_hi:[0,1,1]
    v_pk_fma_f32 v[234:235], v[28:29], v[232:233], v[234:235] op_sel:[1,1,0] op_sel_hi:[1,0,1] neg_lo:[0,1,0]
    v_pk_fma_f32 v[232:233], v[28:29], v[234:235], v[210:211] op_sel_hi:[0,1,1]
    v_pk_fma_f32 v[232:233], v[28:29], v[234:235], v[232:233] op_sel:[1,1,0] op_sel_hi:[1,0,1] neg_lo:[0,1,0]
    v_pk_fma_f32 v[234:235], v[28:29], v[232:233], v[208:209] op_sel_hi:[0,1,1]
    v_pk_fma_f32 v[234:235], v[28:29], v[232:233], v[234:235] op_sel:[1,1,0] op_sel_hi:[1,0,1] neg_lo:[0,1,0]
    v_pk_fma_f32 v[232:233], v[28:29], v[234:235], v[206:207] op_sel_hi:[0,1,1]
    v_pk_fma_f32 v[232:233], v[28:29], v[234:235], v[232:233] op_sel:[1,1,0] op_sel_hi:[1,0,1] neg_lo:[0,1,0]
    v_pk_fma_f32 v[234:235], v[28:29], v[232:233], v[204:205] op_sel_hi:[0,1,1]
    v_pk_fma_f32 v[234:235], v[28:29], v[232:233], v[234:235] op_sel:[1,1,0] op_sel_hi:[1,0,1] neg_lo:[0,1,0]
    v_pk_fma_f32 v[232:233], v[28:29], v[234:235], v[202:203] op_sel_hi:[0,1,1]
    v_pk_fma_f32 v[232:233], v[28:29], v[234:235], v[232:233] op_sel:[1,1,0] op_sel_hi:[1,0,1] neg_lo:[0,1,0]
    v_pk_fma_f32 v[234:235], v[28:29], v[232:233], v[200:201] op_sel_hi:[0,1,1]
    v_pk_fma_f32 v[234:235], v[28:29], v[232:233], v[234:235] op_sel:[1,1,0] op_sel_hi:[1,0,1] neg_lo:[0,1,0]
    ds_read2_b32 v[200:201], v244 offset0:0 offset1:8
    ds_read2_b32 v[202:203], v244 offset0:80 offset1:88
    ds_read2_b32 v[204:205], v244 offset0:160 offset1:168
    ds_read2_b32 v[206:207], v244 offset0:240 offset1:248
    ds_read2_b32 v[208:209], v245 offset0:0 offset1:8
    ds_read2_b32 v[210:211], v245 offset0:80 offset1:88
    ds_read2_b32 v[212:213], v245 offset0:160 offset1:168
    ds_read2_b32 v[214:215], v245 offset0:240 offset1:248
    ds_read2_b32 v[216:217], v246 offset0:0 offset1:8
    ds_read2_b32 v[218:219], v246 offset0:80 offset1:88
    ds_read2_b32 v[220:221], v246 offset0:160 offset1:168
    ds_read2_b32 v[222:223], v246 offset0:240 offset1:248
    ds_read2_b32 v[224:225], v247 offset0:0 offset1:8
    ds_read2_b32 v[226:227], v247 offset0:80 offset1:88
    ds_read2_b32 v[228:229], v247 offset0:160 offset1:168
    ds_read2_b32 v[230:231], v247 offset0:240 offset1:248
    s_waitcnt lgkmcnt(0)
    s_nop 0
    ds_write2_b32 v244, v234, v235 offset0:0 offset1:8
    v_pk_fma_f32 v[232:233], v[26:27], v[234:235], v[200:201] op_sel_hi:[0,1,1]
    v_pk_fma_f32 v[232:233], v[26:27], v[234:235], v[232:233] op_sel:[1,1,0] op_sel_hi:[1,0,1] neg_lo:[0,1,0]
    ds_write2_b32 v244, v232, v233 offset0:80 offset1:88
    v_pk_fma_f32 v[234:235], v[26:27], v[232:233], v[202:203] op_sel_hi:[0,1,1]
    v_pk_fma_f32 v[234:235], v[26:27], v[232:233], v[234:235] op_sel:[1,1,0] op_sel_hi:[1,0,1] neg_lo:[0,1,0]
    ds_write2_b32 v244, v234, v235 offset0:160 offset1:168
    v_pk_fma_f32 v[232:233], v[26:27], v[234:235], v[204:205] op_sel_hi:[0,1,1]
    v_pk_fma_f32 v[232:233], v[26:27], v[234:235], v[232:233] op_sel:[1,1,0] op_sel_hi:[1,0,1] neg_lo:[0,1,0]
    ds_write2_b32 v244, v232, v233 offset0:240 offset1:248
    v_pk_fma_f32 v[234:235], v[26:27], v[232:233], v[206:207] op_sel_hi:[0,1,1]
    v_pk_fma_f32 v[234:235], v[26:27], v[232:233], v[234:235] op_sel:[1,1,0] op_sel_hi:[1,0,1] neg_lo:[0,1,0]
    ds_write2_b32 v245, v234, v235 offset0:0 offset1:8
    v_pk_fma_f32 v[232:233], v[26:27], v[234:235], v[208:209] op_sel_hi:[0,1,1]
    v_pk_fma_f32 v[232:233], v[26:27], v[234:235], v[232:233] op_sel:[1,1,0] op_sel_hi:[1,0,1] neg_lo:[0,1,0]
    ds_write2_b32 v245, v232, v233 offset0:80 offset1:88
    v_pk_fma_f32 v[234:235], v[26:27], v[232:233], v[210:211] op_sel_hi:[0,1,1]
    v_pk_fma_f32 v[234:235], v[26:27], v[232:233], v[234:235] op_sel:[1,1,0] op_sel_hi:[1,0,1] neg_lo:[0,1,0]
    ds_write2_b32 v245, v234, v235 offset0:160 offset1:168
    v_pk_fma_f32 v[232:233], v[26:27], v[234:235], v[212:213] op_sel_hi:[0,1,1]
    v_pk_fma_f32 v[232:233], v[26:27], v[234:235], v[232:233] op_sel:[1,1,0] op_sel_hi:[1,0,1] neg_lo:[0,1,0]
    ds_write2_b32 v245, v232, v233 offset0:240 offset1:248
    v_pk_fma_f32 v[234:235], v[26:27], v[232:233], v[214:215] op_sel_hi:[0,1,1]
    v_pk_fma_f32 v[234:235], v[26:27], v[232:233], v[234:235] op_sel:[1,1,0] op_sel_hi:[1,0,1] neg_lo:[0,1,0]
    ds_write2_b32 v246, v234, v235 offset0:0 offset1:8
    v_pk_fma_f32 v[232:233], v[26:27], v[234:235], v[216:217] op_sel_hi:[0,1,1]
    v_pk_fma_f32 v[232:233], v[26:27], v[234:235], v[232:233] op_sel:[1,1,0] op_sel_hi:[1,0,1] neg_lo:[0,1,0]
    ds_write2_b32 v246, v232, v233 offset0:80 offset1:88
    v_pk_fma_f32 v[234:235], v[26:27], v[232:233], v[218:219] op_sel_hi:[0,1,1]
    v_pk_fma_f32 v[234:235], v[26:27], v[232:233], v[234:235] op_sel:[1,1,0] op_sel_hi:[1,0,1] neg_lo:[0,1,0]
    ds_write2_b32 v246, v234, v235 offset0:160 offset1:168
    v_pk_fma_f32 v[232:233], v[26:27], v[234:235], v[220:221] op_sel_hi:[0,1,1]
    v_pk_fma_f32 v[232:233], v[26:27], v[234:235], v[232:233] op_sel:[1,1,0] op_sel_hi:[1,0,1] neg_lo:[0,1,0]
    ds_write2_b32 v246, v232, v233 offset0:240 offset1:248
    v_pk_fma_f32 v[234:235], v[26:27], v[232:233], v[222:223] op_sel_hi:[0,1,1]
    v_pk_fma_f32 v[234:235], v[26:27], v[232:233], v[234:235] op_sel:[1,1,0] op_sel_hi:[1,0,1] neg_lo:[0,1,0]
    ds_write2_b32 v247, v234, v235 offset0:0 offset1:8
    v_pk_fma_f32 v[232:233], v[26:27], v[234:235], v[224:225] op_sel_hi:[0,1,1]
    v_pk_fma_f32 v[232:233], v[26:27], v[234:235], v[232:233] op_sel:[1,1,0] op_sel_hi:[1,0,1] neg_lo:[0,1,0]
    ds_write2_b32 v247, v232, v233 offset0:80 offset1:88
    v_pk_fma_f32 v[234:235], v[26:27], v[232:233], v[226:227] op_sel_hi:[0,1,1]
    v_pk_fma_f32 v[234:235], v[26:27], v[232:233], v[234:235] op_sel:[1,1,0] op_sel_hi:[1,0,1] neg_lo:[0,1,0]
    ds_write2_b32 v247, v234, v235 offset0:160 offset1:168
    v_pk_fma_f32 v[232:233], v[26:27], v[234:235], v[228:229] op_sel_hi:[0,1,1]
    v_pk_fma_f32 v[232:233], v[26:27], v[234:235], v[232:233] op_sel:[1,1,0] op_sel_hi:[1,0,1] neg_lo:[0,1,0]
    ds_write2_b32 v247, v232, v233 offset0:240 offset1:248
    s_branch L_carry_end
L_nolb:
    s_nop 0
    ds_read_b64_tr_b16 v[200:201], v148 offset:4096
    ds_read_b64_tr_b16 v[202:203], v148 offset:4864
    ds_read_b64_tr_b16 v[204:205], v149 offset:4096
    ds_read_b64_tr_b16 v[206:207], v149 offset:4864
    ds_read_b64_tr_b16 v[208:209], v148 offset:10240
    ds_read_b64_tr_b16 v[210:211], v148 offset:11008
    ds_read_b64_tr_b16 v[212:213], v149 offset:10240
    ds_read_b64_tr_b16 v[214:215], v149 offset:11008
    ds_read_b64_tr_b16 v[216:217], v148 offset:16384
    ds_read_b64_tr_b16 v[218:219], v148 offset:17152
    ds_read_b64_tr_b16 v[220:221], v149 offset:16384
    ds_read_b64_tr_b16 v[222:223], v149 offset:17152
    s_waitcnt lgkmcnt(8)
    v_mfma_f32_16x16x32_bf16 v[124:127], v[30:33], v[200:203], 0
    ds_read_b64_tr_b16 v[224:225], v148 offset:22528
    ds_read_b64_tr_b16 v[226:227], v148 offset:23296
    v_mfma_f32_16x16x32_bf16 v[128:131], v[30:33], v[204:207], 0
    ds_read_b64_tr_b16 v[228:229], v149 offset:22528
    ds_read_b64_tr_b16 v[230:231], v149 offset:23296
    s_waitcnt lgkmcnt(8)
    v_mfma_f32_16x16x32_bf16 v[124:127], v[30:33], v[208:211], v[124:127]
    ds_read_b64_tr_b16 v[200:201], v148 offset:28672
    ds_read_b64_tr_b16 v[202:203], v148 offset:29440
    v_mfma_f32_16x16x32_bf16 v[128:131], v[30:33], v[212:215], v[128:131]
    ds_read_b64_tr_b16 v[204:205], v149 offset:28672
    ds_read_b64_tr_b16 v[206:207], v149 offset:29440
    s_waitcnt lgkmcnt(8)
    v_mfma_f32_16x16x32_bf16 v[124:127], v[30:33], v[216:219], v[124:127]
    ds_read_b64_tr_b16 v[208:209], v148 offset:34816
    ds_read_b64_tr_b16 v[210:211], v148 offset:35584
    v_mfma_f32_16x16x32_bf16 v[128:131], v[30:33], v[220:223], v[128:131]
    ds_read_b64_tr_b16 v[212:213], v149 offset:34816
    ds_read_b64_tr_b16 v[214:215], v149 offset:35584
    s_waitcnt lgkmcnt(8)
    v_mfma_f32_16x16x32_bf16 v[124:127], v[30:33], v[224:227], v[124:127]
    ds_read_b64_tr_b16 v[216:217], v148 offset:40960
    ds_read_b64_tr_b16 v[218:219], v148 offset:41728
    v_mfma_f32_16x16x32_bf16 v[128:131], v[30:33], v[228:231], v[128:131]
    ds_read_b64_tr_b16 v[220:221], v149 offset:40960
    ds_read_b64_tr_b16 v[222:223], v149 offset:41728
    s_waitcnt lgkmcnt(8)
    v_mfma_f32_16x16x32_bf16 v[124:127], v[30:33], v[200:203], v[124:127]
    ds_read_b64_tr_b16 v[224:225], v148 offset:47104
    ds_read_b64_tr_b16 v[226:227], v148 offset:47872
    v_mfma_f32_16x16x32_bf16 v[128:131], v[30:33], v[204:207], v[128:131]
    ds_read_b64_tr_b16 v[228:229], v149 offset:47104
    ds_read_b64_tr_b16 v[230:231], v149 offset:47872
    s_waitcnt lgkmcnt(8)
    v_mfma_f32_16x16x32_bf16 v[124:127], v[30:33], v[208:211], v[124:127]
    ds_read_b64_tr_b16 v[200:201], v148 offset:53248
    ds_read_b64_tr_b16 v[202:203], v148 offset:54016
    v_mfma_f32_16x16x32_bf16 v[128:131], v[30:33], v[212:215], v[128:131]
    ds_read_b64_tr_b16 v[204:205], v149 offset:53248
    ds_read_b64_tr_b16 v[206:207], v149 offset:54016
    s_waitcnt lgkmcnt(8)
    v_mfma_f32_16x16x32_bf16 v[124:127], v[30:33], v[216:219], v[124:127]
    ds_read_b64_tr_b16 v[208:209], v148 offset:59392
    ds_read_b64_tr_b16 v[210:211], v148 offset:60160
    v_mfma_f32_16x16x32_bf16 v[128:131], v[30:33], v[220:223], v[128:131]
    ds_read_b64_tr_b16 v[212:213], v149 offset:59392
    ds_read_b64_tr_b16 v[214:215], v149 offset:60160
    s_waitcnt lgkmcnt(8)
    v_mfma_f32_16x16x32_bf16 v[124:127], v[30:33], v[224:227], v[124:127]
    ds_read_b64_tr_b16 v[216:217], v146 offset:28672
    ds_read_b64_tr_b16 v[218:219], v146 offset:29440
    v_mfma_f32_16x16x32_bf16 v[128:131], v[30:33], v[228:231], v[128:131]
    ds_read_b64_tr_b16 v[220:221], v147 offset:28672
    ds_read_b64_tr_b16 v[222:223], v147 offset:29440
    s_waitcnt lgkmcnt(8)
    v_mfma_f32_16x16x32_bf16 v[124:127], v[30:33], v[200:203], v[124:127]
    ds_read_b64_tr_b16 v[224:225], v146 offset:34816
    ds_read_b64_tr_b16 v[226:227], v146 offset:35584
    v_mfma_f32_16x16x32_bf16 v[128:131], v[30:33], v[204:207], v[128:131]
    ds_read_b64_tr_b16 v[228:229], v147 offset:34816
    ds_read_b64_tr_b16 v[230:231], v147 offset:35584
    s_waitcnt lgkmcnt(8)
    v_mfma_f32_16x16x32_bf16 v[124:127], v[30:33], v[208:211], v[124:127]
    ds_read_b64_tr_b16 v[200:201], v146 offset:40960
    ds_read_b64_tr_b16 v[202:203], v146 offset:41728
    v_mfma_f32_16x16x32_bf16 v[128:131], v[30:33], v[212:215], v[128:131]
    ds_read_b64_tr_b16 v[204:205], v147 offset:40960
    ds_read_b64_tr_b16 v[206:207], v147 offset:41728
    s_waitcnt lgkmcnt(8)
    v_mfma_f32_16x16x32_bf16 v[124:127], v[30:33], v[216:219], v[124:127]
    ds_read_b64_tr_b16 v[208:209], v146 offset:47104
    ds_read_b64_tr_b16 v[210:211], v146 offset:47872
    v_mfma_f32_16x16x32_bf16 v[128:131], v[30:33], v[220:223], v[128:131]
    ds_read_b64_tr_b16 v[212:213], v147 offset:47104
    ds_read_b64_tr_b16 v[214:215], v147 offset:47872
    s_waitcnt lgkmcnt(8)
    v_mfma_f32_16x16x32_bf16 v[124:127], v[30:33], v[224:227], v[124:127]
    ds_read_b64_tr_b16 v[216:217], v146 offset:57344
    ds_read_b64_tr_b16 v[218:219], v146 offset:58112
    v_mfma_f32_16x16x32_bf16 v[128:131], v[30:33], v[228:231], v[128:131]
    ds_read_b64_tr_b16 v[220:221], v147 offset:57344
    ds_read_b64_tr_b16 v[222:223], v147 offset:58112
    s_waitcnt lgkmcnt(8)
    v_mfma_f32_16x16x32_bf16 v[124:127], v[30:33], v[200:203], v[124:127]
    ds_read_b64_tr_b16 v[224:225], v146 offset:63488
    ds_read_b64_tr_b16 v[226:227], v146 offset:64256
    v_mfma_f32_16x16x32_bf16 v[128:131], v[30:33], v[204:207], v[128:131]
    ds_read_b64_tr_b16 v[228:229], v147 offset:63488
    ds_read_b64_tr_b16 v[230:231], v147 offset:64256
    s_waitcnt lgkmcnt(8)
    v_mfma_f32_16x16x32_bf16 v[124:127], v[30:33], v[208:211], v[124:127]
    ds_read_b64_tr_b16 v[200:201], v146 offset:0
    ds_read_b64_tr_b16 v[202:203], v146 offset:768
    v_mfma_f32_16x16x32_bf16 v[128:131], v[30:33], v[212:215], v[128:131]
    ds_read_b64_tr_b16 v[204:205], v147 offset:0
    ds_read_b64_tr_b16 v[206:207], v147 offset:768
    s_waitcnt lgkmcnt(8)
    v_mfma_f32_16x16x32_bf16 v[124:127], v[30:33], v[216:219], v[124:127]
    ds_read_b64_tr_b16 v[208:209], v146 offset:6144
    ds_read_b64_tr_b16 v[210:211], v146 offset:6912
    v_mfma_f32_16x16x32_bf16 v[128:131], v[30:33], v[220:223], v[128:131]
    ds_read_b64_tr_b16 v[212:213], v147 offset:6144
    ds_read_b64_tr_b16 v[214:215], v147 offset:6912
    s_waitcnt lgkmcnt(8)
    v_mfma_f32_16x16x32_bf16 v[124:127], v[30:33], v[224:227], v[124:127]
    ds_read_b64_tr_b16 v[216:217], v146 offset:12288
    ds_read_b64_tr_b16 v[218:219], v146 offset:13056
    v_mfma_f32_16x16x32_bf16 v[128:131], v[30:33], v[228:231], v[128:131]
    ds_read_b64_tr_b16 v[220:221], v147 offset:12288
    ds_read_b64_tr_b16 v[222:223], v147 offset:13056
    s_waitcnt lgkmcnt(8)
    v_mfma_f32_16x16x32_bf16 v[124:127], v[30:33], v[200:203], v[124:127]
    ds_read_b64_tr_b16 v[224:225], v146 offset:18432
    ds_read_b64_tr_b16 v[226:227], v146 offset:19200
    v_mfma_f32_16x16x32_bf16 v[128:131], v[30:33], v[204:207], v[128:131]
    ds_read_b64_tr_b16 v[228:229], v147 offset:18432
    ds_read_b64_tr_b16 v[230:231], v147 offset:19200
    s_waitcnt lgkmcnt(8)
    v_mfma_f32_16x16x32_bf16 v[124:127], v[30:33], v[208:211], v[124:127]
    v_mfma_f32_16x16x32_bf16 v[128:131], v[30:33], v[212:215], v[128:131]
    s_waitcnt lgkmcnt(4)
    v_mfma_f32_16x16x32_bf16 v[124:127], v[30:33], v[216:219], v[124:127]
    v_mfma_f32_16x16x32_bf16 v[128:131], v[30:33], v[220:223], v[128:131]
    s_waitcnt lgkmcnt(0)
    v_mfma_f32_16x16x32_bf16 v[124:127], v[30:33], v[224:227], v[124:127]
    v_mfma_f32_16x16x32_bf16 v[128:131], v[30:33], v[228:231], v[128:131]
    s_lshl_b32 s32, s27, 7
    s_add_u32 s32, s32, 148608
    v_lshl_add_u32 v7, v3, 2, s32
    s_nop 4
    s_mov_b64 exec, 0xffff
    ds_write2_b32 v7, v124, v128 offset0:0 offset1:16
    s_mov_b64 exec, -1
L_carry_end:
    s_nop 0
    buffer_load_dwordx4 a[4:7], v34, s[12:15], s66 offen offset:1024 sc1
    buffer_load_dwordx4 a[8:11], v34, s[12:15], s66 offen offset:2048 sc1
    buffer_load_dwordx4 a[12:15], v34, s[12:15], s66 offen offset:3072 sc1
    buffer_load_dwordx4 a[16:19], v35, s[12:15], s66 offen offset:0 sc1
    s_add_u32 s66, s70, 10240
    buffer_load_dwordx4 a[20:23], v34, s[12:15], s66 offen offset:0 sc1
    s_waitcnt lgkmcnt(0)
    s_barrier
    ds_read_b32 v172, v239 offset:0
    ds_read_b32 v173, v239 offset:64
    ds_read_b32 v174, v239 offset:128
    ds_read_b32 v175, v239 offset:192
    ds_read_b32 v176, v239 offset:256
    s_waitcnt lgkmcnt(0)
    v_fmac_f32 v36, v180, v172
    buffer_load_dwordx4 a[24:27], v34, s[12:15], s66 offen offset:1024 sc1
    v_fmac_f32 v44, v184, v173
    v_fmac_f32 v52, v188, v174
    v_fmac_f32 v60, v192, v175
    v_fmac_f32 v68, v196, v176
    v_fmac_f32_dpp v36, v172, v181 row_ror:8 row_mask:0xf bank_mask:0xf
    v_fmac_f32_dpp v44, v173, v185 row_ror:8 row_mask:0xf bank_mask:0xf
    buffer_load_dwordx4 a[28:31], v34, s[12:15], s66 offen offset:2048 sc1
    v_fmac_f32_dpp v52, v174, v189 row_ror:8 row_mask:0xf bank_mask:0xf
    v_fmac_f32_dpp v60, v175, v193 row_ror:8 row_mask:0xf bank_mask:0xf
    v_fmac_f32_dpp v68, v176, v197 row_ror:8 row_mask:0xf bank_mask:0xf
    v_fmac_f32 v37, v180, v36
    v_fmac_f32 v45, v184, v44
    v_fmac_f32 v53, v188, v52
    v_fmac_f32 v61, v192, v60
    buffer_load_dwordx4 a[32:35], v34, s[12:15], s66 offen offset:3072 sc1
    v_fmac_f32_e64 v69, v196, v68
    v_fmac_f32_dpp v37, v36, v181 row_ror:8 row_mask:0xf bank_mask:0xf
    v_fmac_f32_dpp v45, v44, v185 row_ror:8 row_mask:0xf bank_mask:0xf
    v_fmac_f32_dpp v53, v52, v189 row_ror:8 row_mask:0xf bank_mask:0xf
    v_fmac_f32_dpp v61, v60, v193 row_ror:8 row_mask:0xf bank_mask:0xf
    v_fmac_f32_dpp v69, v68, v197 row_ror:8 row_mask:0xf bank_mask:0xf
    v_fmac_f32_e64 v38, v180, v37
    buffer_load_dwordx4 a[36:39], v35, s[12:15], s66 offen offset:0 sc1
    v_fmac_f32 v46, v184, v45
    v_fmac_f32 v54, v188, v53
    v_fmac_f32 v62, v192, v61
    v_fmac_f32 v70, v196, v69
    v_fmac_f32_dpp v38, v37, v181 row_ror:8 row_mask:0xf bank_mask:0xf
    v_fmac_f32_dpp v46, v45, v185 row_ror:8 row_mask:0xf bank_mask:0xf
    s_add_u32 s66, s70, 15360
    buffer_load_dwordx4 a[40:43], v34, s[12:15], s66 offen offset:0 sc1
    v_fmac_f32_dpp v54, v53, v189 row_ror:8 row_mask:0xf bank_mask:0xf
    v_fmac_f32_dpp v62, v61, v193 row_ror:8 row_mask:0xf bank_mask:0xf
    v_fmac_f32_dpp v70, v69, v197 row_ror:8 row_mask:0xf bank_mask:0xf
    v_fmac_f32 v39, v180, v38
    v_fmac_f32 v47, v184, v46
    v_fmac_f32 v55, v188, v54
    v_fmac_f32 v63, v192, v62
    buffer_load_dwordx4 a[44:47], v34, s[12:15], s66 offen offset:1024 sc1
    v_fmac_f32_e64 v71, v196, v70
    v_fmac_f32_dpp v39, v38, v181 row_ror:8 row_mask:0xf bank_mask:0xf
    v_fmac_f32_dpp v47, v46, v185 row_ror:8 row_mask:0xf bank_mask:0xf
    v_fmac_f32_dpp v55, v54, v189 row_ror:8 row_mask:0xf bank_mask:0xf
    v_fmac_f32_dpp v63, v62, v193 row_ror:8 row_mask:0xf bank_mask:0xf
    v_fmac_f32_dpp v71, v70, v197 row_ror:8 row_mask:0xf bank_mask:0xf
    v_fmac_f32_e64 v40, v180, v39
    buffer_load_dwordx4 a[48:51], v34, s[12:15], s66 offen offset:2048 sc1
    v_fmac_f32 v48, v184, v47
    v_fmac_f32 v56, v188, v55
    v_fmac_f32 v64, v192, v63
    v_fmac_f32 v72, v196, v71
    v_fmac_f32_dpp v40, v39, v181 row_ror:8 row_mask:0xf bank_mask:0xf
    v_fmac_f32_dpp v48, v47, v185 row_ror:8 row_mask:0xf bank_mask:0xf
    buffer_load_dwordx4 a[52:55], v34, s[12:15], s66 offen offset:3072 sc1
    v_fmac_f32_dpp v56, v55, v189 row_ror:8 row_mask:0xf bank_mask:0xf
    v_fmac_f32_dpp v64, v63, v193 row_ror:8 row_mask:0xf bank_mask:0xf
    v_fmac_f32_dpp v72, v71, v197 row_ror:8 row_mask:0xf bank_mask:0xf
    v_fmac_f32 v41, v180, v40
    v_fmac_f32 v49, v184, v48
    v_fmac_f32 v57, v188, v56
    v_fmac_f32 v65, v192, v64
    buffer_load_dwordx4 a[56:59], v35, s[12:15], s66 offen offset:0 sc1
    v_fmac_f32_e64 v73, v196, v72
    v_fmac_f32_dpp v41, v40, v181 row_ror:8 row_mask:0xf bank_mask:0xf
    v_fmac_f32_dpp v49, v48, v185 row_ror:8 row_mask:0xf bank_mask:0xf
    v_fmac_f32_dpp v57, v56, v189 row_ror:8 row_mask:0xf bank_mask:0xf
    v_fmac_f32_dpp v65, v64, v193 row_ror:8 row_mask:0xf bank_mask:0xf
    v_fmac_f32_dpp v73, v72, v197 row_ror:8 row_mask:0xf bank_mask:0xf
    v_fmac_f32_e64 v42, v180, v41
    s_add_u32 s66, s70, 20480
    buffer_load_dwordx4 a[184:187], v34, s[12:15], s66 offen offset:0 sc1
    v_fmac_f32 v50, v184, v49
    v_fmac_f32 v58, v188, v57
    v_fmac_f32 v66, v192, v65
    v_fmac_f32 v74, v196, v73
    v_fmac_f32_dpp v42, v41, v181 row_ror:8 row_mask:0xf bank_mask:0xf
    v_fmac_f32_dpp v50, v49, v185 row_ror:8 row_mask:0xf bank_mask:0xf
    buffer_load_dwordx4 a[188:191], v34, s[12:15], s66 offen offset:1024 sc1
    v_fmac_f32_dpp v58, v57, v189 row_ror:8 row_mask:0xf bank_mask:0xf
    v_fmac_f32_dpp v66, v65, v193 row_ror:8 row_mask:0xf bank_mask:0xf
    v_fmac_f32_dpp v74, v73, v197 row_ror:8 row_mask:0xf bank_mask:0xf
    v_fmac_f32 v43, v180, v42
    v_fmac_f32 v51, v184, v50
    v_fmac_f32 v59, v188, v58
    v_fmac_f32 v67, v192, v66
    buffer_load_dwordx4 a[192:195], v34, s[12:15], s66 offen offset:2048 sc1
    v_fmac_f32_e64 v75, v196, v74
    v_fmac_f32_dpp v43, v42, v181 row_ror:8 row_mask:0xf bank_mask:0xf
    v_fmac_f32_dpp v51, v50, v185 row_ror:8 row_mask:0xf bank_mask:0xf
    v_fmac_f32_dpp v59, v58, v189 row_ror:8 row_mask:0xf bank_mask:0xf
    v_fmac_f32_dpp v67, v66, v193 row_ror:8 row_mask:0xf bank_mask:0xf
    v_fmac_f32_dpp v75, v74, v197 row_ror:8 row_mask:0xf bank_mask:0xf
    v_pk_mul_f32 v[152:153], v[36:37], v[182:183] op_sel_hi:[1,0]
    v_pk_mul_f32 v[154:155], v[38:39], v[182:183] op_sel_hi:[1,0]
    v_pk_mul_f32 v[156:157], v[40:41], v[182:183] op_sel_hi:[1,0]
    v_pk_mul_f32 v[158:159], v[42:43], v[182:183] op_sel_hi:[1,0]
    v_fmac_f32_dpp v152, v36, v183 row_ror:8 row_mask:0xf bank_mask:0xf
    v_fmac_f32_dpp v153, v37, v183 row_ror:8 row_mask:0xf bank_mask:0xf
    v_fmac_f32_dpp v154, v38, v183 row_ror:8 row_mask:0xf bank_mask:0xf
    v_fmac_f32_dpp v155, v39, v183 row_ror:8 row_mask:0xf bank_mask:0xf
    v_fmac_f32_dpp v156, v40, v183 row_ror:8 row_mask:0xf bank_mask:0xf
    v_fmac_f32_dpp v157, v41, v183 row_ror:8 row_mask:0xf bank_mask:0xf
    v_fmac_f32_dpp v158, v42, v183 row_ror:8 row_mask:0xf bank_mask:0xf
    v_fmac_f32_dpp v159, v43, v183 row_ror:8 row_mask:0xf bank_mask:0xf
    v_cvt_pk_bf16_f32 v36, v152, v153
    v_cvt_pk_bf16_f32 v37, v154, v155
    v_cvt_pk_bf16_f32 v38, v156, v157
    v_cvt_pk_bf16_f32 v39, v158, v159
    ds_write_b128 v240, v[36:39] offset:0
    ds_read_b64_tr_b16 v[200:201], v241 offset:0
    ds_read_b64_tr_b16 v[202:203], v242 offset:256
    v_pk_mul_f32 v[160:161], v[44:45], v[186:187] op_sel_hi:[1,0]
    v_pk_mul_f32 v[162:163], v[46:47], v[186:187] op_sel_hi:[1,0]
    v_pk_mul_f32 v[164:165], v[48:49], v[186:187] op_sel_hi:[1,0]
    v_pk_mul_f32 v[166:167], v[50:51], v[186:187] op_sel_hi:[1,0]
    v_fmac_f32_dpp v160, v44, v187 row_ror:8 row_mask:0xf bank_mask:0xf
    v_fmac_f32_dpp v161, v45, v187 row_ror:8 row_mask:0xf bank_mask:0xf
    v_fmac_f32_dpp v162, v46, v187 row_ror:8 row_mask:0xf bank_mask:0xf
    v_fmac_f32_dpp v163, v47, v187 row_ror:8 row_mask:0xf bank_mask:0xf
    v_fmac_f32_dpp v164, v48, v187 row_ror:8 row_mask:0xf bank_mask:0xf
    v_fmac_f32_dpp v165, v49, v187 row_ror:8 row_mask:0xf bank_mask:0xf
    v_fmac_f32_dpp v166, v50, v187 row_ror:8 row_mask:0xf bank_mask:0xf
    v_fmac_f32_dpp v167, v51, v187 row_ror:8 row_mask:0xf bank_mask:0xf
    v_cvt_pk_bf16_f32 v44, v160, v161
    v_cvt_pk_bf16_f32 v45, v162, v163
    v_cvt_pk_bf16_f32 v46, v164, v165
    v_cvt_pk_bf16_f32 v47, v166, v167
    s_waitcnt lgkmcnt(0)
    buffer_store_dwordx4 v[200:203], v243, s[12:15], s30 offen sc1
    s_add_u32 s30, s30, s31
    s_sub_u32 s31, 4096, s31
    ds_write_b128 v240, v[44:47] offset:1024
    ds_read_b64_tr_b16 v[204:205], v241 offset:1024
    ds_read_b64_tr_b16 v[206:207], v242 offset:1280
    v_pk_mul_f32 v[152:153], v[52:53], v[190:191] op_sel_hi:[1,0]
    v_pk_mul_f32 v[154:155], v[54:55], v[190:191] op_sel_hi:[1,0]
    v_pk_mul_f32 v[156:157], v[56:57], v[190:191] op_sel_hi:[1,0]
    v_pk_mul_f32 v[158:159], v[58:59], v[190:191] op_sel_hi:[1,0]
    v_fmac_f32_dpp v152, v52, v191 row_ror:8 row_mask:0xf bank_mask:0xf
    v_fmac_f32_dpp v153, v53, v191 row_ror:8 row_mask:0xf bank_mask:0xf
    v_fmac_f32_dpp v154, v54, v191 row_ror:8 row_mask:0xf bank_mask:0xf
    v_fmac_f32_dpp v155, v55, v191 row_ror:8 row_mask:0xf bank_mask:0xf
    v_fmac_f32_dpp v156, v56, v191 row_ror:8 row_mask:0xf bank_mask:0xf
    v_fmac_f32_dpp v157, v57, v191 row_ror:8 row_mask:0xf bank_mask:0xf
    v_fmac_f32_dpp v158, v58, v191 row_ror:8 row_mask:0xf bank_mask:0xf
    v_fmac_f32_dpp v159, v59, v191 row_ror:8 row_mask:0xf bank_mask:0xf
    v_cvt_pk_bf16_f32 v52, v152, v153
    v_cvt_pk_bf16_f32 v53, v154, v155
    v_cvt_pk_bf16_f32 v54, v156, v157
    v_cvt_pk_bf16_f32 v55, v158, v159
    s_waitcnt lgkmcnt(0)
    buffer_store_dwordx4 v[204:207], v243, s[12:15], s30 offen sc1
    s_add_u32 s30, s30, s31
    s_sub_u32 s31, 4096, s31
    ds_write_b128 v240, v[52:55] offset:2048
    ds_read_b64_tr_b16 v[208:209], v241 offset:2048
    ds_read_b64_tr_b16 v[210:211], v242 offset:2304
    v_pk_mul_f32 v[160:161], v[60:61], v[194:195] op_sel_hi:[1,0]
    v_pk_mul_f32 v[162:163], v[62:63], v[194:195] op_sel_hi:[1,0]
    v_pk_mul_f32 v[164:165], v[64:65], v[194:195] op_sel_hi:[1,0]
    v_pk_mul_f32 v[166:167], v[66:67], v[194:195] op_sel_hi:[1,0]
    v_fmac_f32_dpp v160, v60, v195 row_ror:8 row_mask:0xf bank_mask:0xf
    v_fmac_f32_dpp v161, v61, v195 row_ror:8 row_mask:0xf bank_mask:0xf
    v_fmac_f32_dpp v162, v62, v195 row_ror:8 row_mask:0xf bank_mask:0xf
    v_fmac_f32_dpp v163, v63, v195 row_ror:8 row_mask:0xf bank_mask:0xf
    v_fmac_f32_dpp v164, v64, v195 row_ror:8 row_mask:0xf bank_mask:0xf
    v_fmac_f32_dpp v165, v65, v195 row_ror:8 row_mask:0xf bank_mask:0xf
    v_fmac_f32_dpp v166, v66, v195 row_ror:8 row_mask:0xf bank_mask:0xf
    v_fmac_f32_dpp v167, v67, v195 row_ror:8 row_mask:0xf bank_mask:0xf
    v_cvt_pk_bf16_f32 v60, v160, v161
    v_cvt_pk_bf16_f32 v61, v162, v163
    v_cvt_pk_bf16_f32 v62, v164, v165
    v_cvt_pk_bf16_f32 v63, v166, v167
    s_waitcnt lgkmcnt(0)
    buffer_store_dwordx4 v[208:211], v243, s[12:15], s30 offen sc1
    s_add_u32 s30, s30, s31
    s_sub_u32 s31, 4096, s31
    ds_write_b128 v240, v[60:63] offset:3072
    ds_read_b64_tr_b16 v[212:213], v241 offset:3072
    ds_read_b64_tr_b16 v[214:215], v242 offset:3328
    v_pk_mul_f32 v[152:153], v[68:69], v[198:199] op_sel_hi:[1,0]
    v_pk_mul_f32 v[154:155], v[70:71], v[198:199] op_sel_hi:[1,0]
    v_pk_mul_f32 v[156:157], v[72:73], v[198:199] op_sel_hi:[1,0]
    v_pk_mul_f32 v[158:159], v[74:75], v[198:199] op_sel_hi:[1,0]
    v_fmac_f32_dpp v152, v68, v199 row_ror:8 row_mask:0xf bank_mask:0xf
    v_fmac_f32_dpp v153, v69, v199 row_ror:8 row_mask:0xf bank_mask:0xf
    v_fmac_f32_dpp v154, v70, v199 row_ror:8 row_mask:0xf bank_mask:0xf
    v_fmac_f32_dpp v155, v71, v199 row_ror:8 row_mask:0xf bank_mask:0xf
    v_fmac_f32_dpp v156, v72, v199 row_ror:8 row_mask:0xf bank_mask:0xf
    v_fmac_f32_dpp v157, v73, v199 row_ror:8 row_mask:0xf bank_mask:0xf
    v_fmac_f32_dpp v158, v74, v199 row_ror:8 row_mask:0xf bank_mask:0xf
    v_fmac_f32_dpp v159, v75, v199 row_ror:8 row_mask:0xf bank_mask:0xf
    v_cvt_pk_bf16_f32 v68, v152, v153
    v_cvt_pk_bf16_f32 v69, v154, v155
    v_cvt_pk_bf16_f32 v70, v156, v157
    v_cvt_pk_bf16_f32 v71, v158, v159
    s_waitcnt lgkmcnt(0)
    buffer_store_dwordx4 v[212:215], v243, s[12:15], s30 offen sc1
    s_add_u32 s30, s30, s31
    s_sub_u32 s31, 4096, s31
    ds_write_b128 v240, v[68:71] offset:4096
    ds_read_b64_tr_b16 v[216:217], v241 offset:4096
    ds_read_b64_tr_b16 v[218:219], v242 offset:4352
    s_waitcnt lgkmcnt(0)
    buffer_store_dwordx4 v[216:219], v243, s[12:15], s30 offen sc1
    s_add_u32 s30, s30, s31
    s_sub_u32 s31, 4096, s31
    v_mfma_f32_16x16x32_bf16 v[76:79], a[160:163], a[64:67], v[76:79]
    ds_read_b64_tr_b16 v[60:61], v144 offset:59392
    s_lshr_b32 s34, s29, 3
    s_lshl_b32 s32, s28, 1
    s_add_u32 s33, s32, s34
    v_mfma_f32_16x16x32_bf16 v[80:83], a[160:163], a[68:71], v[80:83]
    ds_read_b64_tr_b16 v[62:63], v144 offset:60160
    buffer_load_dwordx4 a[196:199], v34, s[12:15], s66 offen offset:3072 sc1
    s_xor_b32 s32, s33, 1
    s_mul_i32 s33, s33, 88
    v_mfma_f32_16x16x32_bf16 v[84:87], a[164:167], a[64:67], v[84:87]
    ds_read_b64_tr_b16 v[64:65], v145 offset:59392
    s_mul_i32 s32, s32, 88
    s_lshl_b32 s35, s34, 2
    s_add_u32 s35, s35, s27
    v_mfma_f32_16x16x32_bf16 v[88:91], a[164:167], a[68:71], v[88:91]
    ds_read_b64_tr_b16 v[66:67], v145 offset:60160
    s_mul_i32 s3, s35, 5
    s_add_u32 s33, s33, s3
    v_mfma_f32_16x16x32_bf16 v[92:95], a[168:171], a[64:67], v[92:95]
    ds_read_b64_tr_b16 v[68:69], v144 offset:59456
    buffer_load_dwordx4 a[200:203], v35, s[12:15], s66 offen offset:0 sc1
    s_add_u32 s32, s32, s3
    s_lshl_b32 s33, s33, 12
    s_lshl_b32 s32, s32, 12
    v_mfma_f32_16x16x32_bf16 v[96:99], a[168:171], a[68:71], v[96:99]
    ds_read_b64_tr_b16 v[70:71], v144 offset:60224
    s_add_u32 s72, s33, 4194304
    s_add_u32 s73, s32, 4194304
    v_mfma_f32_16x16x32_bf16 v[100:103], a[172:175], a[64:67], v[100:103]
    ds_read_b64_tr_b16 v[72:73], v145 offset:59456
    s_mul_i32 s35, s35, 4294952960
    s_add_u32 s35, s35, 163840
    s_add_u32 s78, s72, s35
    v_mfma_f32_16x16x32_bf16 v[104:107], a[172:175], a[68:71], v[104:107]
    ds_read_b64_tr_b16 v[74:75], v145 offset:60224
    s_add_u32 s66, s69, 0
    s_add_u32 s79, s73, s35
    v_and_b32_e64 v17, 31, v2
    v_mfma_f32_16x16x32_bf16 v[108:111], a[176:179], a[64:67], v[108:111]
    ds_read_b64_tr_b16 v[152:153], v144 offset:59520
    buffer_load_dwordx4 a[204:207], v34, s[12:15], s66 offen offset:0 sc1
    v_lshlrev_b32 v17, 2, v17
    s_lshl_b32 s32, s34, 7
    v_add_u32_e64 v17, s32, v17
    v_mfma_f32_16x16x32_bf16 v[112:115], a[176:179], a[68:71], v[112:115]
    ds_read_b64_tr_b16 v[154:155], v144 offset:60288
    v_add_u32 v19, 4096, v17
    s_xor_b32 s32, s29, 8
    v_mfma_f32_16x16x32_bf16 v[116:119], a[180:183], a[64:67], v[116:119]
    ds_read_b64_tr_b16 v[156:157], v145 offset:59520
    s_lshl_b32 s32, s32, 4
    s_add_u32 s32, s32, 4096
    v_and_b32_e64 v18, 3, v2
    v_mfma_f32_16x16x32_bf16 v[120:123], a[180:183], a[68:71], v[120:123]
    ds_read_b64_tr_b16 v[158:159], v145 offset:60288
    v_lshl_add_u32 v18, v18, 2, s32
    v_cmp_gt_u32 vcc, 32, v2
    s_nop 1
    v_cndmask_b32 v19, v18, v19, vcc
    s_waitcnt lgkmcnt(8)
    v_mfma_f32_16x16x32_bf16 v[76:79], v[60:63], a[72:75], v[76:79]
    ds_read_b64_tr_b16 v[36:37], v142 offset:28672
    s_add_u32 s32, s27, 0
    s_and_b32 s32, s32, 3
    s_lshl_b32 s32, s32, 10
    v_mfma_f32_16x16x32_bf16 v[80:83], v[60:63], a[76:79], v[80:83]
    ds_read_b64_tr_b16 v[38:39], v142 offset:29440
    buffer_load_dwordx4 a[208:211], v34, s[12:15], s66 offen offset:1024 sc1
    v_add_u32 v26, s32, v34
    s_mul_i32 s20, s32, 48
    v_mfma_f32_16x16x32_bf16 v[84:87], v[64:67], a[72:75], v[84:87]
    ds_read_b64_tr_b16 v[40:41], v143 offset:28672
    s_lshl_b32 s32, s32, 4
    v_add_u32_e64 v22, s32, v34
    v_mfma_f32_16x16x32_bf16 v[88:91], v[64:67], a[76:79], v[88:91]
    ds_read_b64_tr_b16 v[42:43], v143 offset:29440
    s_add_u32 s32, s27, 1
    s_and_b32 s32, s32, 3
    s_lshl_b32 s32, s32, 10
    s_waitcnt lgkmcnt(8)
    v_mfma_f32_16x16x32_bf16 v[92:95], v[68:71], a[72:75], v[92:95]
    ds_read_b64_tr_b16 v[44:45], v142 offset:28736
    buffer_load_dwordx4 a[212:215], v34, s[12:15], s66 offen offset:2048 sc1
    v_add_u32 v27, s32, v34
    s_mul_i32 s21, s32, 48
    v_mfma_f32_16x16x32_bf16 v[96:99], v[68:71], a[76:79], v[96:99]
    ds_read_b64_tr_b16 v[46:47], v142 offset:29504
    s_lshl_b32 s32, s32, 4
    v_add_u32 v23, s32, v34
    v_mfma_f32_16x16x32_bf16 v[100:103], v[72:75], a[72:75], v[100:103]
    ds_read_b64_tr_b16 v[48:49], v143 offset:28736
    s_add_u32 s32, s27, 2
    s_and_b32 s32, s32, 3
    s_lshl_b32 s32, s32, 10
    v_mfma_f32_16x16x32_bf16 v[104:107], v[72:75], a[76:79], v[104:107]
    ds_read_b64_tr_b16 v[50:51], v143 offset:29504
    v_add_u32 v28, s32, v34
    s_mul_i32 s22, s32, 48
    s_waitcnt lgkmcnt(8)
    v_mfma_f32_16x16x32_bf16 v[108:111], v[152:155], a[72:75], v[108:111]
    ds_read_b64_tr_b16 v[52:53], v142 offset:28800
    buffer_load_dwordx4 a[216:219], v34, s[12:15], s66 offen offset:3072 sc1
    s_lshl_b32 s32, s32, 4
    v_add_u32 v24, s32, v34
    v_mfma_f32_16x16x32_bf16 v[112:115], v[152:155], a[76:79], v[112:115]
    ds_read_b64_tr_b16 v[54:55], v142 offset:29568
    s_add_u32 s32, s27, 3
    s_and_b32 s32, s32, 3
    s_lshl_b32 s32, s32, 10
    v_mfma_f32_16x16x32_bf16 v[116:119], v[156:159], a[72:75], v[116:119]
    ds_read_b64_tr_b16 v[56:57], v143 offset:28800
    v_add_u32 v29, s32, v34
    s_mul_i32 s23, s32, 48
    v_mfma_f32_16x16x32_bf16 v[120:123], v[156:159], a[76:79], v[120:123]
    ds_read_b64_tr_b16 v[58:59], v143 offset:29568
    s_lshl_b32 s32, s32, 4
    v_add_u32 v25, s32, v34
    s_waitcnt lgkmcnt(8)
    v_mfma_f32_16x16x32_bf16 v[76:79], v[36:39], a[80:83], v[76:79]
    ds_read_b64_tr_b16 v[60:61], v142 offset:34816
    v_mfma_f32_16x16x32_bf16 v[80:83], v[36:39], a[84:87], v[80:83]
    ds_read_b64_tr_b16 v[62:63], v142 offset:35584
    buffer_load_dwordx4 a[220:223], v35, s[12:15], s66 offen offset:0 sc1
    v_mfma_f32_16x16x32_bf16 v[84:87], v[40:43], a[80:83], v[84:87]
    ds_read_b64_tr_b16 v[64:65], v143 offset:34816
    v_mfma_f32_16x16x32_bf16 v[88:91], v[40:43], a[84:87], v[88:91]
    ds_read_b64_tr_b16 v[66:67], v143 offset:35584
    s_add_u32 s66, s69, 10240
    s_waitcnt lgkmcnt(8)
    v_mfma_f32_16x16x32_bf16 v[92:95], v[44:47], a[80:83], v[92:95]
    ds_read_b64_tr_b16 v[68:69], v142 offset:34880
    buffer_load_dwordx4 a[160:163], v34, s[12:15], s66 offen offset:0 sc1
    v_mfma_f32_16x16x32_bf16 v[96:99], v[44:47], a[84:87], v[96:99]
    ds_read_b64_tr_b16 v[70:71], v142 offset:35648
    v_mfma_f32_16x16x32_bf16 v[100:103], v[48:51], a[80:83], v[100:103]
    ds_read_b64_tr_b16 v[72:73], v143 offset:34880
    v_mfma_f32_16x16x32_bf16 v[104:107], v[48:51], a[84:87], v[104:107]
    ds_read_b64_tr_b16 v[74:75], v143 offset:35648
    s_waitcnt lgkmcnt(8)
    v_mfma_f32_16x16x32_bf16 v[108:111], v[52:55], a[80:83], v[108:111]
    ds_read_b64_tr_b16 v[152:153], v142 offset:34944
    buffer_load_dwordx4 a[164:167], v34, s[12:15], s66 offen offset:1024 sc1
    v_mfma_f32_16x16x32_bf16 v[112:115], v[52:55], a[84:87], v[112:115]
    ds_read_b64_tr_b16 v[154:155], v142 offset:35712
    v_mfma_f32_16x16x32_bf16 v[116:119], v[56:59], a[80:83], v[116:119]
    ds_read_b64_tr_b16 v[156:157], v143 offset:34944
    v_mfma_f32_16x16x32_bf16 v[120:123], v[56:59], a[84:87], v[120:123]
    ds_read_b64_tr_b16 v[158:159], v143 offset:35712
    s_waitcnt lgkmcnt(8)
    v_mfma_f32_16x16x32_bf16 v[76:79], v[60:63], a[88:91], v[76:79]
    ds_read_b64_tr_b16 v[36:37], v142 offset:40960
    v_mfma_f32_16x16x32_bf16 v[80:83], v[60:63], a[92:95], v[80:83]
    ds_read_b64_tr_b16 v[38:39], v142 offset:41728
    buffer_load_dwordx4 a[168:171], v34, s[12:15], s66 offen offset:2048 sc1
    v_mfma_f32_16x16x32_bf16 v[84:87], v[64:67], a[88:91], v[84:87]
    ds_read_b64_tr_b16 v[40:41], v143 offset:40960
    v_mfma_f32_16x16x32_bf16 v[88:91], v[64:67], a[92:95], v[88:91]
    ds_read_b64_tr_b16 v[42:43], v143 offset:41728
    s_waitcnt lgkmcnt(8)
    v_mfma_f32_16x16x32_bf16 v[92:95], v[68:71], a[88:91], v[92:95]
    ds_read_b64_tr_b16 v[44:45], v142 offset:41024
    buffer_load_dwordx4 a[172:175], v34, s[12:15], s66 offen offset:3072 sc1
    v_mfma_f32_16x16x32_bf16 v[96:99], v[68:71], a[92:95], v[96:99]
    ds_read_b64_tr_b16 v[46:47], v142 offset:41792
    v_mfma_f32_16x16x32_bf16 v[100:103], v[72:75], a[88:91], v[100:103]
    ds_read_b64_tr_b16 v[48:49], v143 offset:41024
    v_mfma_f32_16x16x32_bf16 v[104:107], v[72:75], a[92:95], v[104:107]
    ds_read_b64_tr_b16 v[50:51], v143 offset:41792
    s_waitcnt lgkmcnt(8)
    v_mfma_f32_16x16x32_bf16 v[108:111], v[152:155], a[88:91], v[108:111]
    ds_read_b64_tr_b16 v[52:53], v142 offset:41088
    buffer_load_dwordx4 a[176:179], v35, s[12:15], s66 offen offset:0 sc1
    v_mfma_f32_16x16x32_bf16 v[112:115], v[152:155], a[92:95], v[112:115]
    ds_read_b64_tr_b16 v[54:55], v142 offset:41856
    v_mfma_f32_16x16x32_bf16 v[116:119], v[156:159], a[88:91], v[116:119]
    ds_read_b64_tr_b16 v[56:57], v143 offset:41088
    v_mfma_f32_16x16x32_bf16 v[120:123], v[156:159], a[92:95], v[120:123]
    ds_read_b64_tr_b16 v[58:59], v143 offset:41856
    s_waitcnt vmcnt(12)
    v_mov_b32_e64 v8, 1
    s_add_u32 s32, s68, 4096
    s_mov_b64 exec, 1
    buffer_store_dword v8, v6, s[12:15], s32 offen sc1
    s_mov_b64 exec, -1
    s_waitcnt lgkmcnt(8)
    v_mfma_f32_16x16x32_bf16 v[76:79], v[36:39], a[96:99], v[76:79]
    ds_read_b64_tr_b16 v[60:61], v142 offset:47104
    s_mov_b32 m0, s26
    s_nop 0
    v_mfma_f32_16x16x32_bf16 v[80:83], v[36:39], a[100:103], v[80:83]
    ds_read_b64_tr_b16 v[62:63], v142 offset:47872
    buffer_load_dwordx4 v248, s[4:7], s25 offen lds
    v_mfma_f32_16x16x32_bf16 v[84:87], v[40:43], a[96:99], v[84:87]
    ds_read_b64_tr_b16 v[64:65], v143 offset:47104
    buffer_load_dwordx4 v249, s[4:7], s25 offen offset:1024 lds
    v_mfma_f32_16x16x32_bf16 v[88:91], v[40:43], a[100:103], v[88:91]
    ds_read_b64_tr_b16 v[66:67], v143 offset:47872
    s_waitcnt lgkmcnt(8)
    v_mfma_f32_16x16x32_bf16 v[92:95], v[44:47], a[96:99], v[92:95]
    ds_read_b64_tr_b16 v[68:69], v142 offset:47168
    s_mov_b32 exec_hi, 0
    buffer_load_dwordx4 v250, s[4:7], s25 offen offset:2048 lds
    s_mov_b32 exec_hi, -1
    s_add_u32 m0, s26, 2560
    s_mov_b32 s16, s52
    s_mov_b32 s17, s53
    s_mov_b32 s18, 1280
    v_mfma_f32_16x16x32_bf16 v[96:99], v[44:47], a[100:103], v[96:99]
    ds_read_b64_tr_b16 v[70:71], v142 offset:47936
    s_mov_b64 exec, 0x3ff
    buffer_load_dwordx4 v34, s[16:19], s24 offen lds
    s_mov_b64 exec, -1
    v_mfma_f32_16x16x32_bf16 v[100:103], v[48:51], a[96:99], v[100:103]
    ds_read_b64_tr_b16 v[72:73], v143 offset:47168
    s_add_u32 s66, s69, 5120
    v_mfma_f32_16x16x32_bf16 v[104:107], v[48:51], a[100:103], v[104:107]
    ds_read_b64_tr_b16 v[74:75], v143 offset:47936
    buffer_load_dwordx4 a[60:63], v34, s[12:15], s66 offen offset:0 sc1
    s_waitcnt lgkmcnt(8)
    v_mfma_f32_16x16x32_bf16 v[108:111], v[52:55], a[96:99], v[108:111]
    ds_read_b64_tr_b16 v[152:153], v142 offset:47232
    buffer_load_dwordx4 a[64:67], v34, s[12:15], s66 offen offset:1024 sc1
    v_mfma_f32_16x16x32_bf16 v[112:115], v[52:55], a[100:103], v[112:115]
    ds_read_b64_tr_b16 v[154:155], v142 offset:48000
    v_mfma_f32_16x16x32_bf16 v[116:119], v[56:59], a[96:99], v[116:119]
    ds_read_b64_tr_b16 v[156:157], v143 offset:47232
    buffer_load_dwordx4 a[68:71], v34, s[12:15], s66 offen offset:2048 sc1
    v_mfma_f32_16x16x32_bf16 v[120:123], v[56:59], a[100:103], v[120:123]
    ds_read_b64_tr_b16 v[158:159], v143 offset:48000
    s_waitcnt lgkmcnt(8)
    v_mfma_f32_16x16x32_bf16 v[76:79], v[60:63], a[104:107], v[76:79]
    ds_read_b64_tr_b16 v[36:37], v142 offset:57344
    v_mfma_f32_16x16x32_bf16 v[80:83], v[60:63], a[108:111], v[80:83]
    ds_read_b64_tr_b16 v[38:39], v142 offset:58112
    buffer_load_dwordx4 a[72:75], v34, s[12:15], s66 offen offset:3072 sc1
    v_mfma_f32_16x16x32_bf16 v[84:87], v[64:67], a[104:107], v[84:87]
    ds_read_b64_tr_b16 v[40:41], v143 offset:57344
    v_mfma_f32_16x16x32_bf16 v[88:91], v[64:67], a[108:111], v[88:91]
    ds_read_b64_tr_b16 v[42:43], v143 offset:58112
    s_waitcnt lgkmcnt(8)
    v_mfma_f32_16x16x32_bf16 v[92:95], v[68:71], a[104:107], v[92:95]
    ds_read_b64_tr_b16 v[44:45], v142 offset:57408
    buffer_load_dwordx4 a[76:79], v35, s[12:15], s66 offen offset:0 sc1
    v_mfma_f32_16x16x32_bf16 v[96:99], v[68:71], a[108:111], v[96:99]
    ds_read_b64_tr_b16 v[46:47], v142 offset:58176
    v_mfma_f32_16x16x32_bf16 v[100:103], v[72:75], a[104:107], v[100:103]
    ds_read_b64_tr_b16 v[48:49], v143 offset:57408
    v_mfma_f32_16x16x32_bf16 v[104:107], v[72:75], a[108:111], v[104:107]
    ds_read_b64_tr_b16 v[50:51], v143 offset:58176
    s_add_u32 s66, s69, 15360
    s_waitcnt lgkmcnt(8)
    v_mfma_f32_16x16x32_bf16 v[108:111], v[152:155], a[104:107], v[108:111]
    ds_read_b64_tr_b16 v[52:53], v142 offset:57472
    buffer_load_dwordx4 a[80:83], v34, s[12:15], s66 offen offset:0 sc1
    v_mfma_f32_16x16x32_bf16 v[112:115], v[152:155], a[108:111], v[112:115]
    ds_read_b64_tr_b16 v[54:55], v142 offset:58240
    v_mfma_f32_16x16x32_bf16 v[116:119], v[156:159], a[104:107], v[116:119]
    ds_read_b64_tr_b16 v[56:57], v143 offset:57472
    v_mfma_f32_16x16x32_bf16 v[120:123], v[156:159], a[108:111], v[120:123]
    ds_read_b64_tr_b16 v[58:59], v143 offset:58240
    s_waitcnt lgkmcnt(8)
    v_mfma_f32_16x16x32_bf16 v[76:79], v[36:39], a[112:115], v[76:79]
    ds_read_b64_tr_b16 v[60:61], v142 offset:63488
    v_mfma_f32_16x16x32_bf16 v[80:83], v[36:39], a[116:119], v[80:83]
    ds_read_b64_tr_b16 v[62:63], v142 offset:64256
    buffer_load_dwordx4 a[84:87], v34, s[12:15], s66 offen offset:1024 sc1
    v_mfma_f32_16x16x32_bf16 v[84:87], v[40:43], a[112:115], v[84:87]
    ds_read_b64_tr_b16 v[64:65], v143 offset:63488
    v_mfma_f32_16x16x32_bf16 v[88:91], v[40:43], a[116:119], v[88:91]
    ds_read_b64_tr_b16 v[66:67], v143 offset:64256
    s_waitcnt lgkmcnt(8)
    v_mfma_f32_16x16x32_bf16 v[92:95], v[44:47], a[112:115], v[92:95]
    ds_read_b64_tr_b16 v[68:69], v142 offset:63552
    buffer_load_dwordx4 a[88:91], v34, s[12:15], s66 offen offset:2048 sc1
    v_mfma_f32_16x16x32_bf16 v[96:99], v[44:47], a[116:119], v[96:99]
    ds_read_b64_tr_b16 v[70:71], v142 offset:64320
    v_mfma_f32_16x16x32_bf16 v[100:103], v[48:51], a[112:115], v[100:103]
    ds_read_b64_tr_b16 v[72:73], v143 offset:63552
    v_mfma_f32_16x16x32_bf16 v[104:107], v[48:51], a[116:119], v[104:107]
    ds_read_b64_tr_b16 v[74:75], v143 offset:64320
    s_waitcnt lgkmcnt(8)
    v_mfma_f32_16x16x32_bf16 v[108:111], v[52:55], a[112:115], v[108:111]
    ds_read_b64_tr_b16 v[152:153], v142 offset:63616
    buffer_load_dwordx4 a[92:95], v34, s[12:15], s66 offen offset:3072 sc1
    v_mfma_f32_16x16x32_bf16 v[112:115], v[52:55], a[116:119], v[112:115]
    ds_read_b64_tr_b16 v[154:155], v142 offset:64384
    v_mfma_f32_16x16x32_bf16 v[116:119], v[56:59], a[112:115], v[116:119]
    ds_read_b64_tr_b16 v[156:157], v143 offset:63616
    v_mfma_f32_16x16x32_bf16 v[120:123], v[56:59], a[116:119], v[120:123]
    ds_read_b64_tr_b16 v[158:159], v143 offset:64384
    s_waitcnt lgkmcnt(8)
    v_mfma_f32_16x16x32_bf16 v[76:79], v[60:63], a[120:123], v[76:79]
    ds_read_b64_tr_b16 v[36:37], v142 offset:0
    v_mfma_f32_16x16x32_bf16 v[80:83], v[60:63], a[124:127], v[80:83]
    ds_read_b64_tr_b16 v[38:39], v142 offset:768
    buffer_load_dwordx4 a[96:99], v35, s[12:15], s66 offen offset:0 sc1
    v_mfma_f32_16x16x32_bf16 v[84:87], v[64:67], a[120:123], v[84:87]
    ds_read_b64_tr_b16 v[40:41], v143 offset:0
    v_mfma_f32_16x16x32_bf16 v[88:91], v[64:67], a[124:127], v[88:91]
    ds_read_b64_tr_b16 v[42:43], v143 offset:768
    s_add_u32 s66, s69, 20480
    s_waitcnt lgkmcnt(8)
    v_mfma_f32_16x16x32_bf16 v[92:95], v[68:71], a[120:123], v[92:95]
    ds_read_b64_tr_b16 v[44:45], v142 offset:64
    buffer_load_dwordx4 a[100:103], v34, s[12:15], s66 offen offset:0 sc1
    v_mfma_f32_16x16x32_bf16 v[96:99], v[68:71], a[124:127], v[96:99]
    ds_read_b64_tr_b16 v[46:47], v142 offset:832
    v_mfma_f32_16x16x32_bf16 v[100:103], v[72:75], a[120:123], v[100:103]
    ds_read_b64_tr_b16 v[48:49], v143 offset:64
    v_mfma_f32_16x16x32_bf16 v[104:107], v[72:75], a[124:127], v[104:107]
    ds_read_b64_tr_b16 v[50:51], v143 offset:832
    s_waitcnt lgkmcnt(8)
    v_mfma_f32_16x16x32_bf16 v[108:111], v[152:155], a[120:123], v[108:111]
    ds_read_b64_tr_b16 v[52:53], v142 offset:128
    buffer_load_dwordx4 a[104:107], v34, s[12:15], s66 offen offset:1024 sc1
    v_mfma_f32_16x16x32_bf16 v[112:115], v[152:155], a[124:127], v[112:115]
    ds_read_b64_tr_b16 v[54:55], v142 offset:896
    v_mfma_f32_16x16x32_bf16 v[116:119], v[156:159], a[120:123], v[116:119]
    ds_read_b64_tr_b16 v[56:57], v143 offset:128
    v_mfma_f32_16x16x32_bf16 v[120:123], v[156:159], a[124:127], v[120:123]
    ds_read_b64_tr_b16 v[58:59], v143 offset:896
    s_waitcnt lgkmcnt(8)
    v_mfma_f32_16x16x32_bf16 v[76:79], v[36:39], a[128:131], v[76:79]
    ds_read_b64_tr_b16 v[60:61], v142 offset:6144
    v_mfma_f32_16x16x32_bf16 v[80:83], v[36:39], a[132:135], v[80:83]
    ds_read_b64_tr_b16 v[62:63], v142 offset:6912
    buffer_load_dwordx4 a[108:111], v34, s[12:15], s66 offen offset:2048 sc1
    v_mfma_f32_16x16x32_bf16 v[84:87], v[40:43], a[128:131], v[84:87]
    ds_read_b64_tr_b16 v[64:65], v143 offset:6144
    v_mfma_f32_16x16x32_bf16 v[88:91], v[40:43], a[132:135], v[88:91]
    ds_read_b64_tr_b16 v[66:67], v143 offset:6912
    s_waitcnt lgkmcnt(8)
    v_mfma_f32_16x16x32_bf16 v[92:95], v[44:47], a[128:131], v[92:95]
    ds_read_b64_tr_b16 v[68:69], v142 offset:6208
    buffer_load_dwordx4 a[112:115], v34, s[12:15], s66 offen offset:3072 sc1
    v_mfma_f32_16x16x32_bf16 v[96:99], v[44:47], a[132:135], v[96:99]
    ds_read_b64_tr_b16 v[70:71], v142 offset:6976
    v_mfma_f32_16x16x32_bf16 v[100:103], v[48:51], a[128:131], v[100:103]
    ds_read_b64_tr_b16 v[72:73], v143 offset:6208
    v_mfma_f32_16x16x32_bf16 v[104:107], v[48:51], a[132:135], v[104:107]
    ds_read_b64_tr_b16 v[74:75], v143 offset:6976
    s_waitcnt lgkmcnt(8)
    v_mfma_f32_16x16x32_bf16 v[108:111], v[52:55], a[128:131], v[108:111]
    ds_read_b64_tr_b16 v[152:153], v142 offset:6272
    buffer_load_dwordx4 a[116:119], v35, s[12:15], s66 offen offset:0 sc1
    v_mfma_f32_16x16x32_bf16 v[112:115], v[52:55], a[132:135], v[112:115]
    ds_read_b64_tr_b16 v[154:155], v142 offset:7040
    v_mfma_f32_16x16x32_bf16 v[116:119], v[56:59], a[128:131], v[116:119]
    ds_read_b64_tr_b16 v[156:157], v143 offset:6272
    v_mfma_f32_16x16x32_bf16 v[120:123], v[56:59], a[132:135], v[120:123]
    ds_read_b64_tr_b16 v[158:159], v143 offset:7040
    s_waitcnt lgkmcnt(8)
    v_mfma_f32_16x16x32_bf16 v[76:79], v[60:63], a[136:139], v[76:79]
    ds_read_b64_tr_b16 v[36:37], v142 offset:12288
    v_mfma_f32_16x16x32_bf16 v[80:83], v[60:63], a[140:143], v[80:83]
    ds_read_b64_tr_b16 v[38:39], v142 offset:13056
    v_mfma_f32_16x16x32_bf16 v[84:87], v[64:67], a[136:139], v[84:87]
    ds_read_b64_tr_b16 v[40:41], v143 offset:12288
    v_mfma_f32_16x16x32_bf16 v[88:91], v[64:67], a[140:143], v[88:91]
    ds_read_b64_tr_b16 v[42:43], v143 offset:13056
    s_waitcnt lgkmcnt(8)
    v_mfma_f32_16x16x32_bf16 v[92:95], v[68:71], a[136:139], v[92:95]
    ds_read_b64_tr_b16 v[44:45], v142 offset:12352
    v_mfma_f32_16x16x32_bf16 v[96:99], v[68:71], a[140:143], v[96:99]
    ds_read_b64_tr_b16 v[46:47], v142 offset:13120
    v_mfma_f32_16x16x32_bf16 v[100:103], v[72:75], a[136:139], v[100:103]
    ds_read_b64_tr_b16 v[48:49], v143 offset:12352
    v_mfma_f32_16x16x32_bf16 v[104:107], v[72:75], a[140:143], v[104:107]
    ds_read_b64_tr_b16 v[50:51], v143 offset:13120
    s_waitcnt lgkmcnt(8)
    v_mfma_f32_16x16x32_bf16 v[108:111], v[152:155], a[136:139], v[108:111]
    ds_read_b64_tr_b16 v[52:53], v142 offset:12416
    v_mfma_f32_16x16x32_bf16 v[112:115], v[152:155], a[140:143], v[112:115]
    ds_read_b64_tr_b16 v[54:55], v142 offset:13184
    v_mfma_f32_16x16x32_bf16 v[116:119], v[156:159], a[136:139], v[116:119]
    ds_read_b64_tr_b16 v[56:57], v143 offset:12416
    v_mfma_f32_16x16x32_bf16 v[120:123], v[156:159], a[140:143], v[120:123]
    ds_read_b64_tr_b16 v[58:59], v143 offset:13184
    s_waitcnt lgkmcnt(8)
    v_mfma_f32_16x16x32_bf16 v[76:79], v[36:39], a[144:147], v[76:79]
    ds_read_b64_tr_b16 v[60:61], v142 offset:18432
    s_add_u32 s66, s69, 25600
    v_lshlrev_b32_e64 v7, 4, v4
    v_mfma_f32_16x16x32_bf16 v[80:83], v[36:39], a[148:151], v[80:83]
    ds_read_b64_tr_b16 v[62:63], v142 offset:19200
    buffer_load_dwordx4 a[120:123], v34, s[12:15], s66 offen offset:0 sc1
    v_mfma_f32_16x16x32_bf16 v[84:87], v[40:43], a[144:147], v[84:87]
    ds_read_b64_tr_b16 v[64:65], v143 offset:18432
    v_mfma_f32_16x16x32_bf16 v[88:91], v[40:43], a[148:151], v[88:91]
    ds_read_b64_tr_b16 v[66:67], v143 offset:19200
    buffer_load_dwordx4 a[124:127], v34, s[12:15], s66 offen offset:1024 sc1
    s_waitcnt lgkmcnt(8)
    v_mfma_f32_16x16x32_bf16 v[92:95], v[44:47], a[144:147], v[92:95]
    ds_read_b64_tr_b16 v[68:69], v142 offset:18496
    v_mfma_f32_16x16x32_bf16 v[96:99], v[44:47], a[148:151], v[96:99]
    ds_read_b64_tr_b16 v[70:71], v142 offset:19264
    v_mfma_f32_16x16x32_bf16 v[100:103], v[48:51], a[144:147], v[100:103]
    ds_read_b64_tr_b16 v[72:73], v143 offset:18496
    buffer_load_dwordx4 a[128:131], v34, s[12:15], s66 offen offset:2048 sc1
    v_add_u32 v7, 148736, v7
    v_mfma_f32_16x16x32_bf16 v[104:107], v[48:51], a[148:151], v[104:107]
    ds_read_b64_tr_b16 v[74:75], v143 offset:19264
    s_waitcnt lgkmcnt(8)
    v_mfma_f32_16x16x32_bf16 v[108:111], v[52:55], a[144:147], v[108:111]
    ds_read_b64_tr_b16 v[152:153], v142 offset:18560
    v_mfma_f32_16x16x32_bf16 v[112:115], v[52:55], a[148:151], v[112:115]
    ds_read_b64_tr_b16 v[154:155], v142 offset:19328
    s_cmp_lg_u32 s27, 2
    s_cbranch_scc1 L_pl_2
    buffer_load_dword v14, v19, s[12:15], s68 offen sc1
    s_branch L_pl_2e
L_pl_2:
    buffer_load_dword v21, v20, s[4:7], 0 offen
L_pl_2e:
    v_mfma_f32_16x16x32_bf16 v[116:119], v[56:59], a[144:147], v[116:119]
    ds_read_b64_tr_b16 v[156:157], v143 offset:18560
    v_mfma_f32_16x16x32_bf16 v[120:123], v[56:59], a[148:151], v[120:123]
    ds_read_b64_tr_b16 v[158:159], v143 offset:19328
    s_waitcnt lgkmcnt(8)
    v_mfma_f32_16x16x32_bf16 v[76:79], v[60:63], a[152:155], v[76:79]
    ds_read_b128 v[124:127], v7 offset:0
    v_mfma_f32_16x16x32_bf16 v[80:83], v[60:63], a[156:159], v[80:83]
    buffer_load_dwordx4 a[132:135], v34, s[12:15], s66 offen offset:3072 sc1
    v_mfma_f32_16x16x32_bf16 v[84:87], v[64:67], a[152:155], v[84:87]
    ds_read_b128 v[128:131], v7 offset:64
    v_mfma_f32_16x16x32_bf16 v[88:91], v[64:67], a[156:159], v[88:91]
    s_waitcnt lgkmcnt(6)
    v_mfma_f32_16x16x32_bf16 v[92:95], v[68:71], a[152:155], v[92:95]
    ds_read_b128 v[132:135], v7 offset:128
    v_mfma_f32_16x16x32_bf16 v[96:99], v[68:71], a[156:159], v[96:99]
    v_mfma_f32_16x16x32_bf16 v[100:103], v[72:75], a[152:155], v[100:103]
    ds_read_b128 v[160:163], v7 offset:192
    buffer_load_dwordx4 a[136:139], v35, s[12:15], s66 offen offset:0 sc1
    v_mfma_f32_16x16x32_bf16 v[104:107], v[72:75], a[156:159], v[104:107]
    s_waitcnt lgkmcnt(4)
    v_mfma_f32_16x16x32_bf16 v[108:111], v[152:155], a[152:155], v[108:111]
    ds_read_b128 v[164:167], v7 offset:256
    v_mfma_f32_16x16x32_bf16 v[112:115], v[152:155], a[156:159], v[112:115]
    v_mfma_f32_16x16x32_bf16 v[116:119], v[156:159], a[152:155], v[116:119]
    ds_read_b128 v[228:231], v7 offset:320
    v_mfma_f32_16x16x32_bf16 v[120:123], v[156:159], a[156:159], v[120:123]
    s_cmp_lg_u32 s27, 2
    s_cbranch_scc1 L_p4d
    s_waitcnt vmcnt(2)
    s_mov_b32 s32, 0
L_p4:
    v_cmp_ne_u32 vcc, 1, v14
    s_add_u32 s32, s32, 1
    s_cmp_eq_u64 vcc, 0
    s_cbranch_scc1 L_p4d
    s_cmp_gt_u32 s32, 200000
    s_cbranch_scc1 L_p4d
    buffer_load_dword v14, v19, s[12:15], s68 offen sc1
    s_waitcnt vmcnt(0)
    s_branch L_p4
L_p4d:
    s_barrier
    s_add_u32 s67, s73, 0
    s_nop 0
    buffer_load_dwordx4 v[180:183], v26, s[12:15], s67 offen sc1
    buffer_load_dwordx4 v[184:187], v27, s[12:15], s67 offen sc1
    buffer_load_dwordx4 v[188:191], v28, s[12:15], s67 offen sc1
    buffer_load_dwordx4 v[192:195], v29, s[12:15], s67 offen sc1
    s_add_u32 s67, s73, 4096
    buffer_load_dwordx4 v[196:199], v26, s[12:15], s67 offen sc1
    buffer_load_dwordx4 v[200:203], v27, s[12:15], s67 offen sc1
    buffer_load_dwordx4 v[204:207], v28, s[12:15], s67 offen sc1
    buffer_load_dwordx4 v[208:211], v29, s[12:15], s67 offen sc1
    s_add_u32 s67, s72, 0
    buffer_load_dwordx4 v[212:215], v26, s[12:15], s67 offen sc1
    buffer_load_dwordx4 v[216:219], v27, s[12:15], s67 offen sc1
    buffer_load_dwordx4 v[220:223], v28, s[12:15], s67 offen sc1
    buffer_load_dwordx4 v[224:227], v29, s[12:15], s67 offen sc1
    s_and_b32 s34, s27, 1
    s_mul_i32 s34, s34, 96256
    s_mul_i32 s33, s29, 3072
    s_add_u32 s33, s33, s74
    s_add_u32 s33, s33, s34
    s_add_u32 s33, s33, 163840
    s_add_u32 s34, s33, 49152
    s_waitcnt lgkmcnt(0)
    s_waitcnt vmcnt(33)
    ds_read_b64 v[232:233], v254 offset:0
    ds_read_b64 v[234:235], v255 offset:2560
    ds_read_b64 v[236:237], v254 offset:32
    ds_read_b64 v[238:239], v255 offset:2592
    ds_read_b64 v[240:241], v254 offset:64
    ds_read_b64 v[242:243], v255 offset:2624
    ds_read_b64 v[244:245], v254 offset:96
    ds_read_b64 v[246:247], v255 offset:2656
    ds_read_b64 v[176:177], v254 offset:128
    ds_read_b64 v[178:179], v255 offset:2688
    v_pk_fma_f32 v[76:77], v[124:125], v[168:169], v[76:77] op_sel:[0,0,0] op_sel_hi:[1,0,1] neg_lo:[0,1,0] neg_hi:[0,1,0]
    v_pk_fma_f32 v[78:79], v[126:127], v[168:169], v[78:79] op_sel:[0,0,0] op_sel_hi:[1,0,1] neg_lo:[0,1,0] neg_hi:[0,1,0]
    v_pk_fma_f32 v[84:85], v[128:129], v[168:169], v[84:85] op_sel:[0,0,0] op_sel_hi:[1,0,1] neg_lo:[0,1,0] neg_hi:[0,1,0]
    v_pk_fma_f32 v[86:87], v[130:131], v[168:169], v[86:87] op_sel:[0,0,0] op_sel_hi:[1,0,1] neg_lo:[0,1,0] neg_hi:[0,1,0]
    v_pk_mul_f32 v[76:77], v[76:77], v[170:171] op_sel:[0,0] op_sel_hi:[1,0]
    v_pk_mul_f32 v[78:79], v[78:79], v[170:171] op_sel:[0,0] op_sel_hi:[1,0]
    v_pk_mul_f32 v[84:85], v[84:85], v[170:171] op_sel:[0,0] op_sel_hi:[1,0]
    v_pk_mul_f32 v[86:87], v[86:87], v[170:171] op_sel:[0,0] op_sel_hi:[1,0]
    v_cvt_pk_bf16_f32 v76, v76, v77
    v_cvt_pk_bf16_f32 v77, v78, v79
    v_cvt_pk_bf16_f32 v78, v84, v85
    v_cvt_pk_bf16_f32 v79, v86, v87
    v_pk_max_i16 v76, v76, 0
    v_pk_max_i16 v77, v77, 0
    v_pk_max_i16 v78, v78, 0
    v_pk_max_i16 v79, v79, 0
    buffer_store_dwordx4 v[76:79], v34, s[12:15], s33 offen offset:0 sc1
    v_pk_fma_f32 v[80:81], v[124:125], v[168:169], v[80:81] op_sel:[0,1,0] op_sel_hi:[1,1,1] neg_lo:[0,1,0] neg_hi:[0,1,0]
    v_pk_fma_f32 v[82:83], v[126:127], v[168:169], v[82:83] op_sel:[0,1,0] op_sel_hi:[1,1,1] neg_lo:[0,1,0] neg_hi:[0,1,0]
    v_pk_fma_f32 v[88:89], v[128:129], v[168:169], v[88:89] op_sel:[0,1,0] op_sel_hi:[1,1,1] neg_lo:[0,1,0] neg_hi:[0,1,0]
    v_pk_fma_f32 v[90:91], v[130:131], v[168:169], v[90:91] op_sel:[0,1,0] op_sel_hi:[1,1,1] neg_lo:[0,1,0] neg_hi:[0,1,0]
    v_pk_mul_f32 v[80:81], v[80:81], v[170:171] op_sel:[0,1] op_sel_hi:[1,1]
    v_pk_mul_f32 v[82:83], v[82:83], v[170:171] op_sel:[0,1] op_sel_hi:[1,1]
    v_pk_mul_f32 v[88:89], v[88:89], v[170:171] op_sel:[0,1] op_sel_hi:[1,1]
    v_pk_mul_f32 v[90:91], v[90:91], v[170:171] op_sel:[0,1] op_sel_hi:[1,1]
    v_cvt_pk_bf16_f32 v80, v80, v81
    v_cvt_pk_bf16_f32 v81, v82, v83
    v_cvt_pk_bf16_f32 v82, v88, v89
    v_cvt_pk_bf16_f32 v83, v90, v91
    v_pk_max_i16 v80, v80, 0
    v_pk_max_i16 v81, v81, 0
    v_pk_max_i16 v82, v82, 0
    v_pk_max_i16 v83, v83, 0
    buffer_store_dwordx4 v[80:83], v34, s[12:15], s34 offen offset:0 sc1
    v_pk_fma_f32 v[92:93], v[132:133], v[168:169], v[92:93] op_sel:[0,0,0] op_sel_hi:[1,0,1] neg_lo:[0,1,0] neg_hi:[0,1,0]
    v_pk_fma_f32 v[94:95], v[134:135], v[168:169], v[94:95] op_sel:[0,0,0] op_sel_hi:[1,0,1] neg_lo:[0,1,0] neg_hi:[0,1,0]
    v_pk_fma_f32 v[100:101], v[160:161], v[168:169], v[100:101] op_sel:[0,0,0] op_sel_hi:[1,0,1] neg_lo:[0,1,0] neg_hi:[0,1,0]
    v_pk_fma_f32 v[102:103], v[162:163], v[168:169], v[102:103] op_sel:[0,0,0] op_sel_hi:[1,0,1] neg_lo:[0,1,0] neg_hi:[0,1,0]
    v_pk_mul_f32 v[92:93], v[92:93], v[170:171] op_sel:[0,0] op_sel_hi:[1,0]
    v_pk_mul_f32 v[94:95], v[94:95], v[170:171] op_sel:[0,0] op_sel_hi:[1,0]
    v_pk_mul_f32 v[100:101], v[100:101], v[170:171] op_sel:[0,0] op_sel_hi:[1,0]
    v_pk_mul_f32 v[102:103], v[102:103], v[170:171] op_sel:[0,0] op_sel_hi:[1,0]
    v_cvt_pk_bf16_f32 v92, v92, v93
    v_cvt_pk_bf16_f32 v93, v94, v95
    v_cvt_pk_bf16_f32 v94, v100, v101
    v_cvt_pk_bf16_f32 v95, v102, v103
    v_pk_max_i16 v92, v92, 0
    v_pk_max_i16 v93, v93, 0
    v_pk_max_i16 v94, v94, 0
    v_pk_max_i16 v95, v95, 0
    buffer_store_dwordx4 v[92:95], v34, s[12:15], s33 offen offset:1024 sc1
    v_pk_fma_f32 v[96:97], v[132:133], v[168:169], v[96:97] op_sel:[0,1,0] op_sel_hi:[1,1,1] neg_lo:[0,1,0] neg_hi:[0,1,0]
    v_pk_fma_f32 v[98:99], v[134:135], v[168:169], v[98:99] op_sel:[0,1,0] op_sel_hi:[1,1,1] neg_lo:[0,1,0] neg_hi:[0,1,0]
    v_pk_fma_f32 v[104:105], v[160:161], v[168:169], v[104:105] op_sel:[0,1,0] op_sel_hi:[1,1,1] neg_lo:[0,1,0] neg_hi:[0,1,0]
    v_pk_fma_f32 v[106:107], v[162:163], v[168:169], v[106:107] op_sel:[0,1,0] op_sel_hi:[1,1,1] neg_lo:[0,1,0] neg_hi:[0,1,0]
    v_pk_mul_f32 v[96:97], v[96:97], v[170:171] op_sel:[0,1] op_sel_hi:[1,1]
    v_pk_mul_f32 v[98:99], v[98:99], v[170:171] op_sel:[0,1] op_sel_hi:[1,1]
    v_pk_mul_f32 v[104:105], v[104:105], v[170:171] op_sel:[0,1] op_sel_hi:[1,1]
    v_pk_mul_f32 v[106:107], v[106:107], v[170:171] op_sel:[0,1] op_sel_hi:[1,1]
    v_cvt_pk_bf16_f32 v96, v96, v97
    v_cvt_pk_bf16_f32 v97, v98, v99
    v_cvt_pk_bf16_f32 v98, v104, v105
    v_cvt_pk_bf16_f32 v99, v106, v107
    v_pk_max_i16 v96, v96, 0
    v_pk_max_i16 v97, v97, 0
    v_pk_max_i16 v98, v98, 0
    v_pk_max_i16 v99, v99, 0
    buffer_store_dwordx4 v[96:99], v34, s[12:15], s34 offen offset:1024 sc1
    v_pk_fma_f32 v[108:109], v[164:165], v[168:169], v[108:109] op_sel:[0,0,0] op_sel_hi:[1,0,1] neg_lo:[0,1,0] neg_hi:[0,1,0]
    v_pk_fma_f32 v[110:111], v[166:167], v[168:169], v[110:111] op_sel:[0,0,0] op_sel_hi:[1,0,1] neg_lo:[0,1,0] neg_hi:[0,1,0]
    v_pk_fma_f32 v[116:117], v[228:229], v[168:169], v[116:117] op_sel:[0,0,0] op_sel_hi:[1,0,1] neg_lo:[0,1,0] neg_hi:[0,1,0]
    v_pk_fma_f32 v[118:119], v[230:231], v[168:169], v[118:119] op_sel:[0,0,0] op_sel_hi:[1,0,1] neg_lo:[0,1,0] neg_hi:[0,1,0]
    v_pk_mul_f32 v[108:109], v[108:109], v[170:171] op_sel:[0,0] op_sel_hi:[1,0]
    v_pk_mul_f32 v[110:111], v[110:111], v[170:171] op_sel:[0,0] op_sel_hi:[1,0]
    v_pk_mul_f32 v[116:117], v[116:117], v[170:171] op_sel:[0,0] op_sel_hi:[1,0]
    v_pk_mul_f32 v[118:119], v[118:119], v[170:171] op_sel:[0,0] op_sel_hi:[1,0]
    v_cvt_pk_bf16_f32 v108, v108, v109
    v_cvt_pk_bf16_f32 v109, v110, v111
    v_cvt_pk_bf16_f32 v110, v116, v117
    v_cvt_pk_bf16_f32 v111, v118, v119
    v_pk_max_i16 v108, v108, 0
    v_pk_max_i16 v109, v109, 0
    v_pk_max_i16 v110, v110, 0
    v_pk_max_i16 v111, v111, 0
    buffer_store_dwordx4 v[108:111], v34, s[12:15], s33 offen offset:2048 sc1
    v_pk_fma_f32 v[112:113], v[164:165], v[168:169], v[112:113] op_sel:[0,1,0] op_sel_hi:[1,1,1] neg_lo:[0,1,0] neg_hi:[0,1,0]
    v_pk_fma_f32 v[114:115], v[166:167], v[168:169], v[114:115] op_sel:[0,1,0] op_sel_hi:[1,1,1] neg_lo:[0,1,0] neg_hi:[0,1,0]
    v_pk_fma_f32 v[120:121], v[228:229], v[168:169], v[120:121] op_sel:[0,1,0] op_sel_hi:[1,1,1] neg_lo:[0,1,0] neg_hi:[0,1,0]
    v_pk_fma_f32 v[122:123], v[230:231], v[168:169], v[122:123] op_sel:[0,1,0] op_sel_hi:[1,1,1] neg_lo:[0,1,0] neg_hi:[0,1,0]
    v_pk_mul_f32 v[112:113], v[112:113], v[170:171] op_sel:[0,1] op_sel_hi:[1,1]
    v_pk_mul_f32 v[114:115], v[114:115], v[170:171] op_sel:[0,1] op_sel_hi:[1,1]
    v_pk_mul_f32 v[120:121], v[120:121], v[170:171] op_sel:[0,1] op_sel_hi:[1,1]
    v_pk_mul_f32 v[122:123], v[122:123], v[170:171] op_sel:[0,1] op_sel_hi:[1,1]
    v_cvt_pk_bf16_f32 v112, v112, v113
    v_cvt_pk_bf16_f32 v113, v114, v115
    v_cvt_pk_bf16_f32 v114, v120, v121
    v_cvt_pk_bf16_f32 v115, v122, v123
    v_pk_max_i16 v112, v112, 0
    v_pk_max_i16 v113, v113, 0
    v_pk_max_i16 v114, v114, 0
    v_pk_max_i16 v115, v115, 0
    buffer_store_dwordx4 v[112:115], v34, s[12:15], s34 offen offset:2048 sc1
    s_waitcnt lgkmcnt(0)
    s_waitcnt vmcnt(16)
    v_mfma_f32_16x16x32_bf16 v[36:39], a[236:239], v[180:183], 0
    v_and_b32 v119, 0xffff0000, v235
    v_lshlrev_b32_e64 v118, 16, v235
    v_mfma_f32_16x16x32_bf16 v[40:43], a[240:243], v[180:183], 0
    s_add_u32 s67, s73, 8192
    buffer_load_dwordx4 a[140:143], v26, s[12:15], s67 offen sc1
    v_and_b32 v117, 0xffff0000, v234
    v_lshlrev_b32_e64 v116, 16, v234
    v_mfma_f32_16x16x32_bf16 v[44:47], a[244:247], v[180:183], 0
    v_and_b32 v235, 0xffff0000, v233
    v_lshlrev_b32_e64 v234, 16, v233
    v_mfma_f32_16x16x32_bf16 v[48:51], a[248:251], v[180:183], 0
    v_and_b32 v233, 0xffff0000, v232
    v_mfma_f32_16x16x32_bf16 v[52:55], a[252:255], v[180:183], 0
    buffer_load_dwordx4 a[144:147], v27, s[12:15], s67 offen sc1
    v_lshlrev_b32_e64 v232, 16, v232
    v_pk_mul_f32 v[116:117], v[116:117], v[252:253] op_sel:[0,1] op_sel_hi:[1,1]
    v_mfma_f32_16x16x32_bf16 v[56:59], a[236:239], v[184:187], 0
    v_pk_add_f32 v[120:121], v[232:233], v[252:253] op_sel_hi:[1,0] neg_lo:[0,1] neg_hi:[0,1]
    v_pk_fma_f32 v[232:233], v[120:121], v[116:117], v[232:233]
    v_mfma_f32_16x16x32_bf16 v[60:63], a[240:243], v[184:187], 0
    buffer_load_dwordx4 v[180:183], v28, s[12:15], s67 offen sc1
    v_pk_mul_f32 v[118:119], v[118:119], v[252:253] op_sel:[0,1] op_sel_hi:[1,1]
    v_pk_add_f32 v[120:121], v[234:235], v[252:253] op_sel_hi:[1,0] neg_lo:[0,1] neg_hi:[0,1]
    v_mfma_f32_16x16x32_bf16 v[64:67], a[244:247], v[184:187], 0
    v_pk_fma_f32 v[234:235], v[120:121], v[118:119], v[234:235]
    v_mfma_f32_16x16x32_bf16 v[68:71], a[248:251], v[184:187], 0
    v_and_b32 v119, 0xffff0000, v239
    v_lshlrev_b32_e64 v118, 16, v239
    v_mfma_f32_16x16x32_bf16 v[72:75], a[252:255], v[184:187], 0
    buffer_load_dwordx4 v[184:187], v29, s[12:15], s67 offen sc1
    v_and_b32 v117, 0xffff0000, v238
    v_lshlrev_b32 v116, 16, v238
    s_waitcnt vmcnt(18)
    v_mfma_f32_16x16x32_bf16 v[76:79], a[236:239], v[188:191], 0
    v_and_b32 v239, 0xffff0000, v237
    v_lshlrev_b32_e64 v238, 16, v237
    v_mfma_f32_16x16x32_bf16 v[80:83], a[240:243], v[188:191], 0
    v_and_b32 v237, 0xffff0000, v236
    v_mfma_f32_16x16x32_bf16 v[84:87], a[244:247], v[188:191], 0
    v_lshlrev_b32_e64 v236, 16, v236
    v_pk_mul_f32 v[116:117], v[116:117], v[252:253] op_sel:[0,1] op_sel_hi:[1,1]
    v_mfma_f32_16x16x32_bf16 v[88:91], a[248:251], v[188:191], 0
    v_pk_add_f32 v[120:121], v[236:237], v[252:253] op_sel_hi:[1,0] neg_lo:[0,1] neg_hi:[0,1]
    v_pk_fma_f32 v[236:237], v[120:121], v[116:117], v[236:237]
    v_mfma_f32_16x16x32_bf16 v[92:95], a[252:255], v[188:191], 0
    s_add_u32 s67, s72, 4096
    buffer_load_dwordx4 v[188:191], v26, s[12:15], s67 offen sc1
    v_pk_mul_f32 v[118:119], v[118:119], v[252:253] op_sel:[0,1] op_sel_hi:[1,1]
    v_pk_add_f32 v[120:121], v[238:239], v[252:253] op_sel_hi:[1,0] neg_lo:[0,1] neg_hi:[0,1]
    v_mfma_f32_16x16x32_bf16 v[96:99], a[236:239], v[192:195], 0
    v_pk_fma_f32 v[238:239], v[120:121], v[118:119], v[238:239]
    v_mfma_f32_16x16x32_bf16 v[100:103], a[240:243], v[192:195], 0
    v_and_b32 v119, 0xffff0000, v243
    v_lshlrev_b32_e64 v118, 16, v243
    v_mfma_f32_16x16x32_bf16 v[104:107], a[244:247], v[192:195], 0
    v_and_b32 v117, 0xffff0000, v242
    v_lshlrev_b32_e64 v116, 16, v242
    v_mfma_f32_16x16x32_bf16 v[108:111], a[248:251], v[192:195], 0
    v_and_b32 v243, 0xffff0000, v241
    v_lshlrev_b32_e64 v242, 16, v241
    v_mfma_f32_16x16x32_bf16 v[112:115], a[252:255], v[192:195], 0
    buffer_load_dwordx4 v[192:195], v27, s[12:15], s67 offen sc1
    v_and_b32 v241, 0xffff0000, v240
    s_waitcnt vmcnt(18)
    v_mfma_f32_16x16x32_bf16 v[36:39], a[0:3], v[196:199], v[36:39]
    v_lshlrev_b32 v240, 16, v240
    v_pk_mul_f32 v[116:117], v[116:117], v[252:253] op_sel:[0,1] op_sel_hi:[1,1]
    v_mfma_f32_16x16x32_bf16 v[40:43], a[4:7], v[196:199], v[40:43]
    v_pk_add_f32 v[120:121], v[240:241], v[252:253] op_sel_hi:[1,0] neg_lo:[0,1] neg_hi:[0,1]
    v_pk_fma_f32 v[240:241], v[120:121], v[116:117], v[240:241]
    v_mfma_f32_16x16x32_bf16 v[44:47], a[8:11], v[196:199], v[44:47]
    v_pk_mul_f32 v[118:119], v[118:119], v[252:253] op_sel:[0,1] op_sel_hi:[1,1]
    v_pk_add_f32 v[120:121], v[242:243], v[252:253] op_sel_hi:[1,0] neg_lo:[0,1] neg_hi:[0,1]
    v_mfma_f32_16x16x32_bf16 v[48:51], a[12:15], v[196:199], v[48:51]
    v_pk_fma_f32 v[242:243], v[120:121], v[118:119], v[242:243]
    v_mfma_f32_16x16x32_bf16 v[52:55], a[16:19], v[196:199], v[52:55]
    buffer_load_dwordx4 v[196:199], v28, s[12:15], s67 offen sc1
    v_and_b32 v119, 0xffff0000, v247
    v_lshlrev_b32_e64 v118, 16, v247
    v_mfma_f32_16x16x32_bf16 v[56:59], a[0:3], v[200:203], v[56:59]
    v_and_b32 v117, 0xffff0000, v246
    v_lshlrev_b32_e64 v116, 16, v246
    v_mfma_f32_16x16x32_bf16 v[60:63], a[4:7], v[200:203], v[60:63]
    v_and_b32 v247, 0xffff0000, v245
    v_lshlrev_b32_e64 v246, 16, v245
    v_mfma_f32_16x16x32_bf16 v[64:67], a[8:11], v[200:203], v[64:67]
    v_and_b32 v245, 0xffff0000, v244
    v_mfma_f32_16x16x32_bf16 v[68:71], a[12:15], v[200:203], v[68:71]
    v_lshlrev_b32_e64 v244, 16, v244
    v_pk_mul_f32 v[116:117], v[116:117], v[252:253] op_sel:[0,1] op_sel_hi:[1,1]
    v_mfma_f32_16x16x32_bf16 v[72:75], a[16:19], v[200:203], v[72:75]
    buffer_load_dwordx4 v[200:203], v29, s[12:15], s67 offen sc1
    v_pk_add_f32 v[120:121], v[244:245], v[252:253] op_sel_hi:[1,0] neg_lo:[0,1] neg_hi:[0,1]
    v_pk_fma_f32 v[244:245], v[120:121], v[116:117], v[244:245]
    s_waitcnt vmcnt(18)
    v_mfma_f32_16x16x32_bf16 v[76:79], a[0:3], v[204:207], v[76:79]
    v_pk_mul_f32 v[118:119], v[118:119], v[252:253] op_sel:[0,1] op_sel_hi:[1,1]
    v_pk_add_f32 v[120:121], v[246:247], v[252:253] op_sel_hi:[1,0] neg_lo:[0,1] neg_hi:[0,1]
    v_mfma_f32_16x16x32_bf16 v[80:83], a[4:7], v[204:207], v[80:83]
    v_pk_fma_f32 v[246:247], v[120:121], v[118:119], v[246:247]
    v_mfma_f32_16x16x32_bf16 v[84:87], a[8:11], v[204:207], v[84:87]
    v_and_b32 v119, 0xffff0000, v179
    v_lshlrev_b32 v118, 16, v179
    v_mfma_f32_16x16x32_bf16 v[88:91], a[12:15], v[204:207], v[88:91]
    v_and_b32 v117, 0xffff0000, v178
    v_lshlrev_b32_e64 v116, 16, v178
    v_mfma_f32_16x16x32_bf16 v[92:95], a[16:19], v[204:207], v[92:95]
    s_add_u32 s67, s73, 12288
    buffer_load_dwordx4 v[204:207], v26, s[12:15], s67 offen sc1
    v_and_b32 v179, 0xffff0000, v177
    v_lshlrev_b32_e64 v178, 16, v177
    v_mfma_f32_16x16x32_bf16 v[96:99], a[0:3], v[208:211], v[96:99]
    v_and_b32 v177, 0xffff0000, v176
    v_mfma_f32_16x16x32_bf16 v[100:103], a[4:7], v[208:211], v[100:103]
    v_lshlrev_b32_e64 v176, 16, v176
    v_pk_mul_f32 v[116:117], v[116:117], v[252:253] op_sel:[0,1] op_sel_hi:[1,1]
    v_mfma_f32_16x16x32_bf16 v[104:107], a[8:11], v[208:211], v[104:107]
    v_pk_add_f32 v[120:121], v[176:177], v[252:253] op_sel_hi:[1,0] neg_lo:[0,1] neg_hi:[0,1]
    v_pk_fma_f32 v[176:177], v[120:121], v[116:117], v[176:177]
    v_mfma_f32_16x16x32_bf16 v[108:111], a[12:15], v[208:211], v[108:111]
    v_pk_mul_f32 v[118:119], v[118:119], v[252:253] op_sel:[0,1] op_sel_hi:[1,1]
    v_pk_add_f32 v[120:121], v[178:179], v[252:253] op_sel_hi:[1,0] neg_lo:[0,1] neg_hi:[0,1]
    v_mfma_f32_16x16x32_bf16 v[112:115], a[16:19], v[208:211], v[112:115]
    buffer_load_dwordx4 v[208:211], v27, s[12:15], s67 offen sc1
    v_pk_fma_f32 v[178:179], v[120:121], v[118:119], v[178:179]
    s_waitcnt vmcnt(10)
    v_mov_b32 v8, 1
    s_add_u32 s32, s68, 0
    s_mov_b64 exec, 1
    buffer_store_dword v8, v6, s[12:15], s32 offen sc1
    s_mov_b64 exec, -1
    s_waitcnt vmcnt(18)
    v_mfma_f32_16x16x32_bf16 v[232:235], a[236:239], v[212:215], v[232:235]
    s_mov_b32 s8, s60
    v_mfma_f32_16x16x32_bf16 v[236:239], a[240:243], v[212:215], v[236:239]
    s_mov_b32 s9, s61
    v_mfma_f32_16x16x32_bf16 v[240:243], a[244:247], v[212:215], v[240:243]
    s_mov_b32 s10, 5242880
    v_mfma_f32_16x16x32_bf16 v[244:247], a[248:251], v[212:215], v[244:247]
    s_mov_b32 s11, 0x20000
    v_mfma_f32_16x16x32_bf16 v[176:179], a[252:255], v[212:215], v[176:179]
    buffer_load_dwordx4 v[212:215], v28, s[12:15], s67 offen sc1
    v_lshlrev_b32_e64 v9, 3, v2
    v_mfma_f32_16x16x32_bf16 v[116:119], a[236:239], v[216:219], 0
    v_mfma_f32_16x16x32_bf16 v[120:123], a[240:243], v[216:219], 0
    v_mfma_f32_16x16x32_bf16 v[124:127], a[244:247], v[216:219], 0
    v_mfma_f32_16x16x32_bf16 v[128:131], a[248:251], v[216:219], 0
    v_mfma_f32_16x16x32_bf16 v[132:135], a[252:255], v[216:219], 0
    buffer_load_dwordx4 v[216:219], v29, s[12:15], s67 offen sc1
    s_waitcnt vmcnt(18)
    v_mfma_f32_16x16x32_bf16 v[136:139], a[236:239], v[220:223], 0
    v_mfma_f32_16x16x32_bf16 v[140:143], a[240:243], v[220:223], 0
    v_mfma_f32_16x16x32_bf16 v[144:147], a[244:247], v[220:223], 0
    v_mfma_f32_16x16x32_bf16 v[148:151], a[248:251], v[220:223], 0
    v_mfma_f32_16x16x32_bf16 v[152:155], a[252:255], v[220:223], 0
    s_add_u32 s67, s72, 8192
    buffer_load_dwordx4 v[220:223], v26, s[12:15], s67 offen sc1
    v_mfma_f32_16x16x32_bf16 v[156:159], a[236:239], v[224:227], 0
    v_mfma_f32_16x16x32_bf16 v[160:163], a[240:243], v[224:227], 0
    v_mfma_f32_16x16x32_bf16 v[164:167], a[244:247], v[224:227], 0
    v_mfma_f32_16x16x32_bf16 v[168:171], a[248:251], v[224:227], 0
    v_mfma_f32_16x16x32_bf16 v[172:175], a[252:255], v[224:227], 0
    buffer_load_dwordx4 v[224:227], v27, s[12:15], s67 offen sc1
    s_waitcnt vmcnt(12)
    v_mfma_f32_16x16x32_bf16 v[36:39], a[20:23], a[140:143], v[36:39]
    v_mfma_f32_16x16x32_bf16 v[40:43], a[24:27], a[140:143], v[40:43]
    v_mfma_f32_16x16x32_bf16 v[44:47], a[28:31], a[140:143], v[44:47]
    v_mfma_f32_16x16x32_bf16 v[48:51], a[32:35], a[140:143], v[48:51]
    v_mfma_f32_16x16x32_bf16 v[52:55], a[36:39], a[140:143], v[52:55]
    buffer_load_dwordx4 a[140:143], v28, s[12:15], s67 offen sc1
    v_mfma_f32_16x16x32_bf16 v[56:59], a[20:23], a[144:147], v[56:59]
    v_mfma_f32_16x16x32_bf16 v[60:63], a[24:27], a[144:147], v[60:63]
    v_mfma_f32_16x16x32_bf16 v[64:67], a[28:31], a[144:147], v[64:67]
    v_mfma_f32_16x16x32_bf16 v[68:71], a[32:35], a[144:147], v[68:71]
    v_mfma_f32_16x16x32_bf16 v[72:75], a[36:39], a[144:147], v[72:75]
    buffer_load_dwordx4 a[144:147], v29, s[12:15], s67 offen sc1
    s_waitcnt vmcnt(12)
    v_mfma_f32_16x16x32_bf16 v[76:79], a[20:23], v[180:183], v[76:79]
    v_mfma_f32_16x16x32_bf16 v[80:83], a[24:27], v[180:183], v[80:83]
    v_mfma_f32_16x16x32_bf16 v[84:87], a[28:31], v[180:183], v[84:87]
    v_mfma_f32_16x16x32_bf16 v[88:91], a[32:35], v[180:183], v[88:91]
    v_mfma_f32_16x16x32_bf16 v[92:95], a[36:39], v[180:183], v[92:95]
    s_add_u32 s67, s73, 16384
    buffer_load_dwordx4 v[180:183], v26, s[12:15], s67 offen sc1
    v_mfma_f32_16x16x32_bf16 v[96:99], a[20:23], v[184:187], v[96:99]
    v_mfma_f32_16x16x32_bf16 v[100:103], a[24:27], v[184:187], v[100:103]
    v_mfma_f32_16x16x32_bf16 v[104:107], a[28:31], v[184:187], v[104:107]
    v_mfma_f32_16x16x32_bf16 v[108:111], a[32:35], v[184:187], v[108:111]
    v_mfma_f32_16x16x32_bf16 v[112:115], a[36:39], v[184:187], v[112:115]
    buffer_load_dwordx4 v[184:187], v27, s[12:15], s67 offen sc1
    s_waitcnt vmcnt(12)
    v_mfma_f32_16x16x32_bf16 v[232:235], a[0:3], v[188:191], v[232:235]
    v_mfma_f32_16x16x32_bf16 v[236:239], a[4:7], v[188:191], v[236:239]
    v_mfma_f32_16x16x32_bf16 v[240:243], a[8:11], v[188:191], v[240:243]
    v_mfma_f32_16x16x32_bf16 v[244:247], a[12:15], v[188:191], v[244:247]
    v_mfma_f32_16x16x32_bf16 v[176:179], a[16:19], v[188:191], v[176:179]
    buffer_load_dwordx4 v[188:191], v28, s[12:15], s67 offen sc1
    v_mfma_f32_16x16x32_bf16 v[116:119], a[0:3], v[192:195], v[116:119]
    v_mfma_f32_16x16x32_bf16 v[120:123], a[4:7], v[192:195], v[120:123]
    v_mfma_f32_16x16x32_bf16 v[124:127], a[8:11], v[192:195], v[124:127]
    v_mfma_f32_16x16x32_bf16 v[128:131], a[12:15], v[192:195], v[128:131]
    v_mfma_f32_16x16x32_bf16 v[132:135], a[16:19], v[192:195], v[132:135]
    buffer_load_dwordx4 v[192:195], v29, s[12:15], s67 offen sc1
    s_waitcnt vmcnt(12)
    v_mfma_f32_16x16x32_bf16 v[136:139], a[0:3], v[196:199], v[136:139]
    v_mfma_f32_16x16x32_bf16 v[140:143], a[4:7], v[196:199], v[140:143]
    v_mfma_f32_16x16x32_bf16 v[144:147], a[8:11], v[196:199], v[144:147]
    v_mfma_f32_16x16x32_bf16 v[148:151], a[12:15], v[196:199], v[148:151]
    v_mfma_f32_16x16x32_bf16 v[152:155], a[16:19], v[196:199], v[152:155]
    s_add_u32 s67, s72, 12288
    buffer_load_dwordx4 v[196:199], v26, s[12:15], s67 offen sc1
    v_mfma_f32_16x16x32_bf16 v[156:159], a[0:3], v[200:203], v[156:159]
    v_mfma_f32_16x16x32_bf16 v[160:163], a[4:7], v[200:203], v[160:163]
    v_mfma_f32_16x16x32_bf16 v[164:167], a[8:11], v[200:203], v[164:167]
    v_mfma_f32_16x16x32_bf16 v[168:171], a[12:15], v[200:203], v[168:171]
    v_mfma_f32_16x16x32_bf16 v[172:175], a[16:19], v[200:203], v[172:175]
    buffer_load_dwordx4 v[200:203], v27, s[12:15], s67 offen sc1
    s_waitcnt vmcnt(12)
    v_mfma_f32_16x16x32_bf16 v[36:39], a[40:43], v[204:207], v[36:39]
    v_mfma_f32_16x16x32_bf16 v[40:43], a[44:47], v[204:207], v[40:43]
    v_mfma_f32_16x16x32_bf16 v[44:47], a[48:51], v[204:207], v[44:47]
    v_mfma_f32_16x16x32_bf16 v[48:51], a[52:55], v[204:207], v[48:51]
    v_mfma_f32_16x16x32_bf16 v[52:55], a[56:59], v[204:207], v[52:55]
    buffer_load_dwordx4 v[204:207], v28, s[12:15], s67 offen sc1
    v_mfma_f32_16x16x32_bf16 v[56:59], a[40:43], v[208:211], v[56:59]
    v_mfma_f32_16x16x32_bf16 v[60:63], a[44:47], v[208:211], v[60:63]
    v_mfma_f32_16x16x32_bf16 v[64:67], a[48:51], v[208:211], v[64:67]
    v_mfma_f32_16x16x32_bf16 v[68:71], a[52:55], v[208:211], v[68:71]
    v_mfma_f32_16x16x32_bf16 v[72:75], a[56:59], v[208:211], v[72:75]
    buffer_load_dwordx4 v[208:211], v29, s[12:15], s67 offen sc1
    s_waitcnt vmcnt(12)
    v_mfma_f32_16x16x32_bf16 v[76:79], a[40:43], v[212:215], v[76:79]
    v_mfma_f32_16x16x32_bf16 v[80:83], a[44:47], v[212:215], v[80:83]
    v_mfma_f32_16x16x32_bf16 v[84:87], a[48:51], v[212:215], v[84:87]
    v_mfma_f32_16x16x32_bf16 v[88:91], a[52:55], v[212:215], v[88:91]
    v_mfma_f32_16x16x32_bf16 v[92:95], a[56:59], v[212:215], v[92:95]
    s_add_u32 s67, s72, 16384
    buffer_load_dwordx4 v[212:215], v26, s[12:15], s67 offen sc1
    v_mfma_f32_16x16x32_bf16 v[96:99], a[40:43], v[216:219], v[96:99]
    v_mfma_f32_16x16x32_bf16 v[100:103], a[44:47], v[216:219], v[100:103]
    v_mfma_f32_16x16x32_bf16 v[104:107], a[48:51], v[216:219], v[104:107]
    v_mfma_f32_16x16x32_bf16 v[108:111], a[52:55], v[216:219], v[108:111]
    v_mfma_f32_16x16x32_bf16 v[112:115], a[56:59], v[216:219], v[112:115]
    buffer_load_dwordx4 v[216:219], v27, s[12:15], s67 offen sc1
    s_waitcnt vmcnt(12)
    v_mfma_f32_16x16x32_bf16 v[232:235], a[20:23], v[220:223], v[232:235]
    v_mfma_f32_16x16x32_bf16 v[236:239], a[24:27], v[220:223], v[236:239]
    v_mfma_f32_16x16x32_bf16 v[240:243], a[28:31], v[220:223], v[240:243]
    v_mfma_f32_16x16x32_bf16 v[244:247], a[32:35], v[220:223], v[244:247]
    v_mfma_f32_16x16x32_bf16 v[176:179], a[36:39], v[220:223], v[176:179]
    buffer_load_dwordx4 v[220:223], v28, s[12:15], s67 offen sc1
    v_mfma_f32_16x16x32_bf16 v[116:119], a[20:23], v[224:227], v[116:119]
    v_mfma_f32_16x16x32_bf16 v[120:123], a[24:27], v[224:227], v[120:123]
    v_mfma_f32_16x16x32_bf16 v[124:127], a[28:31], v[224:227], v[124:127]
    v_mfma_f32_16x16x32_bf16 v[128:131], a[32:35], v[224:227], v[128:131]
    v_mfma_f32_16x16x32_bf16 v[132:135], a[36:39], v[224:227], v[132:135]
    buffer_load_dwordx4 v[224:227], v29, s[12:15], s67 offen sc1
    s_waitcnt vmcnt(12)
    v_mfma_f32_16x16x32_bf16 v[136:139], a[20:23], a[140:143], v[136:139]
    v_mfma_f32_16x16x32_bf16 v[140:143], a[24:27], a[140:143], v[140:143]
    v_mfma_f32_16x16x32_bf16 v[144:147], a[28:31], a[140:143], v[144:147]
    v_mfma_f32_16x16x32_bf16 v[148:151], a[32:35], a[140:143], v[148:151]
    v_mfma_f32_16x16x32_bf16 v[152:155], a[36:39], a[140:143], v[152:155]
    v_mfma_f32_16x16x32_bf16 v[156:159], a[20:23], a[144:147], v[156:159]
    v_mfma_f32_16x16x32_bf16 v[160:163], a[24:27], a[144:147], v[160:163]
    v_mfma_f32_16x16x32_bf16 v[164:167], a[28:31], a[144:147], v[164:167]
    v_mfma_f32_16x16x32_bf16 v[168:171], a[32:35], a[144:147], v[168:171]
    v_mfma_f32_16x16x32_bf16 v[172:175], a[36:39], a[144:147], v[172:175]
    s_waitcnt vmcnt(10)
    v_mfma_f32_16x16x32_bf16 v[36:39], a[184:187], v[180:183], v[36:39]
    v_mfma_f32_16x16x32_bf16 v[40:43], a[188:191], v[180:183], v[40:43]
    v_mfma_f32_16x16x32_bf16 v[44:47], a[192:195], v[180:183], v[44:47]
    s_cmp_lg_u32 s27, 2
    s_cbranch_scc1 L_pl_3
    buffer_load_dword v14, v17, s[12:15], s68 offen sc1
    s_branch L_pl_3e
L_pl_3:
    buffer_load_dword v21, v20, s[4:7], 0 offen
L_pl_3e:
    v_mfma_f32_16x16x32_bf16 v[48:51], a[196:199], v[180:183], v[48:51]
    v_mfma_f32_16x16x32_bf16 v[52:55], a[200:203], v[180:183], v[52:55]
    v_mfma_f32_16x16x32_bf16 v[56:59], a[184:187], v[184:187], v[56:59]
    v_mfma_f32_16x16x32_bf16 v[60:63], a[188:191], v[184:187], v[60:63]
    v_mfma_f32_16x16x32_bf16 v[64:67], a[192:195], v[184:187], v[64:67]
    v_mfma_f32_16x16x32_bf16 v[68:71], a[196:199], v[184:187], v[68:71]
    v_mfma_f32_16x16x32_bf16 v[72:75], a[200:203], v[184:187], v[72:75]
    s_waitcnt vmcnt(9)
    v_mfma_f32_16x16x32_bf16 v[76:79], a[184:187], v[188:191], v[76:79]
    v_mfma_f32_16x16x32_bf16 v[80:83], a[188:191], v[188:191], v[80:83]
    v_mfma_f32_16x16x32_bf16 v[84:87], a[192:195], v[188:191], v[84:87]
    v_mfma_f32_16x16x32_bf16 v[88:91], a[196:199], v[188:191], v[88:91]
    v_mfma_f32_16x16x32_bf16 v[92:95], a[200:203], v[188:191], v[92:95]
    v_mfma_f32_16x16x32_bf16 v[96:99], a[184:187], v[192:195], v[96:99]
    v_mfma_f32_16x16x32_bf16 v[100:103], a[188:191], v[192:195], v[100:103]
    v_mfma_f32_16x16x32_bf16 v[104:107], a[192:195], v[192:195], v[104:107]
    v_mfma_f32_16x16x32_bf16 v[108:111], a[196:199], v[192:195], v[108:111]
    v_mfma_f32_16x16x32_bf16 v[112:115], a[200:203], v[192:195], v[112:115]
    s_cmp_lg_u32 s27, 2
    s_cbranch_scc1 L_p3d
    s_waitcnt vmcnt(0)
    s_mov_b32 s32, 0
L_p3:
    v_cmp_ne_u32 vcc, 1, v14
    s_add_u32 s32, s32, 1
    s_cmp_eq_u64 vcc, 0
    s_cbranch_scc1 L_p3d
    s_cmp_gt_u32 s32, 200000
    s_cbranch_scc1 L_p3d
    buffer_load_dword v14, v17, s[12:15], s68 offen sc1
    s_waitcnt vmcnt(0)
    s_branch L_p3
L_p3d:
    s_barrier
    s_waitcnt vmcnt(7)
    v_mfma_f32_16x16x32_bf16 v[232:235], a[40:43], v[196:199], v[232:235]
    v_mfma_f32_16x16x32_bf16 v[236:239], a[44:47], v[196:199], v[236:239]
    s_add_u32 s67, s79, s21
    buffer_load_dwordx4 a[140:143], v34, s[12:15], s67 offen offset:0 sc1
    v_mfma_f32_16x16x32_bf16 v[240:243], a[48:51], v[196:199], v[240:243]
    v_mfma_f32_16x16x32_bf16 v[244:247], a[52:55], v[196:199], v[244:247]
    v_mfma_f32_16x16x32_bf16 v[176:179], a[56:59], v[196:199], v[176:179]
    buffer_load_dwordx4 a[144:147], v34, s[12:15], s67 offen offset:1024 sc1
    v_mfma_f32_16x16x32_bf16 v[116:119], a[40:43], v[200:203], v[116:119]
    v_mfma_f32_16x16x32_bf16 v[120:123], a[44:47], v[200:203], v[120:123]
    buffer_load_dwordx4 v[180:183], v34, s[12:15], s67 offen offset:2048 sc1
    v_mfma_f32_16x16x32_bf16 v[124:127], a[48:51], v[200:203], v[124:127]
    v_mfma_f32_16x16x32_bf16 v[128:131], a[52:55], v[200:203], v[128:131]
    v_mfma_f32_16x16x32_bf16 v[132:135], a[56:59], v[200:203], v[132:135]
    buffer_load_dwordx4 v[184:187], v34, s[12:15], s67 offen offset:3072 sc1
    s_waitcnt vmcnt(9)
    v_mfma_f32_16x16x32_bf16 v[136:139], a[40:43], v[204:207], v[136:139]
    v_mfma_f32_16x16x32_bf16 v[140:143], a[44:47], v[204:207], v[140:143]
    buffer_load_dwordx4 v[188:191], v35, s[12:15], s67 offen offset:0 sc1
    v_mfma_f32_16x16x32_bf16 v[144:147], a[48:51], v[204:207], v[144:147]
    v_mfma_f32_16x16x32_bf16 v[148:151], a[52:55], v[204:207], v[148:151]
    v_mfma_f32_16x16x32_bf16 v[152:155], a[56:59], v[204:207], v[152:155]
    buffer_load_dwordx4 v[192:195], v35, s[12:15], s67 offen offset:1024 sc1
    v_mfma_f32_16x16x32_bf16 v[156:159], a[40:43], v[208:211], v[156:159]
    v_mfma_f32_16x16x32_bf16 v[160:163], a[44:47], v[208:211], v[160:163]
    s_add_u32 s67, s79, s22
    buffer_load_dwordx4 v[196:199], v34, s[12:15], s67 offen offset:0 sc1
    v_mfma_f32_16x16x32_bf16 v[164:167], a[48:51], v[208:211], v[164:167]
    v_mfma_f32_16x16x32_bf16 v[168:171], a[52:55], v[208:211], v[168:171]
    v_mfma_f32_16x16x32_bf16 v[172:175], a[56:59], v[208:211], v[172:175]
    buffer_load_dwordx4 v[200:203], v34, s[12:15], s67 offen offset:1024 sc1
    s_waitcnt vmcnt(11)
    v_mfma_f32_16x16x32_bf16 v[232:235], a[184:187], v[212:215], v[232:235]
    v_mfma_f32_16x16x32_bf16 v[236:239], a[188:191], v[212:215], v[236:239]
    buffer_load_dwordx4 v[204:207], v34, s[12:15], s67 offen offset:2048 sc1
    v_mfma_f32_16x16x32_bf16 v[240:243], a[192:195], v[212:215], v[240:243]
    v_mfma_f32_16x16x32_bf16 v[244:247], a[196:199], v[212:215], v[244:247]
    v_mfma_f32_16x16x32_bf16 v[176:179], a[200:203], v[212:215], v[176:179]
    buffer_load_dwordx4 v[208:211], v34, s[12:15], s67 offen offset:3072 sc1
    v_mfma_f32_16x16x32_bf16 v[116:119], a[184:187], v[216:219], v[116:119]
    v_mfma_f32_16x16x32_bf16 v[120:123], a[188:191], v[216:219], v[120:123]
    buffer_load_dwordx4 v[212:215], v35, s[12:15], s67 offen offset:0 sc1
    v_mfma_f32_16x16x32_bf16 v[124:127], a[192:195], v[216:219], v[124:127]
    v_mfma_f32_16x16x32_bf16 v[128:131], a[196:199], v[216:219], v[128:131]
    v_mfma_f32_16x16x32_bf16 v[132:135], a[200:203], v[216:219], v[132:135]
    buffer_load_dwordx4 v[216:219], v35, s[12:15], s67 offen offset:1024 sc1
    s_waitcnt vmcnt(13)
    v_mfma_f32_16x16x32_bf16 v[136:139], a[184:187], v[220:223], v[136:139]
    v_mfma_f32_16x16x32_bf16 v[140:143], a[188:191], v[220:223], v[140:143]
    v_mfma_f32_16x16x32_bf16 v[144:147], a[192:195], v[220:223], v[144:147]
    v_mfma_f32_16x16x32_bf16 v[148:151], a[196:199], v[220:223], v[148:151]
    v_mfma_f32_16x16x32_bf16 v[152:155], a[200:203], v[220:223], v[152:155]
    s_add_u32 s67, s79, s23
    buffer_load_dwordx4 v[220:223], v34, s[12:15], s67 offen offset:0 sc1
    v_mfma_f32_16x16x32_bf16 v[156:159], a[184:187], v[224:227], v[156:159]
    v_mfma_f32_16x16x32_bf16 v[160:163], a[188:191], v[224:227], v[160:163]
    v_mfma_f32_16x16x32_bf16 v[164:167], a[192:195], v[224:227], v[164:167]
    v_mfma_f32_16x16x32_bf16 v[168:171], a[196:199], v[224:227], v[168:171]
    v_mfma_f32_16x16x32_bf16 v[172:175], a[200:203], v[224:227], v[172:175]
    buffer_load_dwordx4 v[224:227], v34, s[12:15], s67 offen offset:1024 sc1
    s_waitcnt vmcnt(12)
    v_mfma_f32_16x16x32_bf16 v[56:59], a[204:207], a[140:143], v[56:59]
    v_mfma_f32_16x16x32_bf16 v[60:63], a[208:211], a[140:143], v[60:63]
    v_mfma_f32_16x16x32_bf16 v[64:67], a[212:215], a[140:143], v[64:67]
    v_mfma_f32_16x16x32_bf16 v[68:71], a[216:219], a[140:143], v[68:71]
    v_mfma_f32_16x16x32_bf16 v[72:75], a[220:223], a[140:143], v[72:75]
    buffer_load_dwordx4 a[140:143], v34, s[12:15], s67 offen offset:2048 sc1
    v_mfma_f32_16x16x32_bf16 v[56:59], a[60:63], a[144:147], v[56:59]
    v_mfma_f32_16x16x32_bf16 v[60:63], a[64:67], a[144:147], v[60:63]
    v_mfma_f32_16x16x32_bf16 v[64:67], a[68:71], a[144:147], v[64:67]
    v_mfma_f32_16x16x32_bf16 v[68:71], a[72:75], a[144:147], v[68:71]
    v_mfma_f32_16x16x32_bf16 v[72:75], a[76:79], a[144:147], v[72:75]
    buffer_load_dwordx4 a[144:147], v34, s[12:15], s67 offen offset:3072 sc1
    s_waitcnt vmcnt(12)
    v_mfma_f32_16x16x32_bf16 v[56:59], a[160:163], v[180:183], v[56:59]
    v_mfma_f32_16x16x32_bf16 v[60:63], a[164:167], v[180:183], v[60:63]
    v_mfma_f32_16x16x32_bf16 v[64:67], a[168:171], v[180:183], v[64:67]
    v_mfma_f32_16x16x32_bf16 v[68:71], a[172:175], v[180:183], v[68:71]
    v_mfma_f32_16x16x32_bf16 v[72:75], a[176:179], v[180:183], v[72:75]
    buffer_load_dwordx4 v[180:183], v35, s[12:15], s67 offen offset:0 sc1
    v_mfma_f32_16x16x32_bf16 v[56:59], a[80:83], v[184:187], v[56:59]
    v_mfma_f32_16x16x32_bf16 v[60:63], a[84:87], v[184:187], v[60:63]
    v_mfma_f32_16x16x32_bf16 v[64:67], a[88:91], v[184:187], v[64:67]
    v_mfma_f32_16x16x32_bf16 v[68:71], a[92:95], v[184:187], v[68:71]
    v_mfma_f32_16x16x32_bf16 v[72:75], a[96:99], v[184:187], v[72:75]
    buffer_load_dwordx4 v[184:187], v35, s[12:15], s67 offen offset:1024 sc1
    s_waitcnt vmcnt(12)
    v_mfma_f32_16x16x32_bf16 v[56:59], a[100:103], v[188:191], v[56:59]
    v_mfma_f32_16x16x32_bf16 v[60:63], a[104:107], v[188:191], v[60:63]
    v_mfma_f32_16x16x32_bf16 v[64:67], a[108:111], v[188:191], v[64:67]
    v_mfma_f32_16x16x32_bf16 v[68:71], a[112:115], v[188:191], v[68:71]
    v_mfma_f32_16x16x32_bf16 v[72:75], a[116:119], v[188:191], v[72:75]
    s_add_u32 s67, s79, s20
    buffer_load_dwordx4 v[188:191], v34, s[12:15], s67 offen offset:0 sc1
    v_mfma_f32_16x16x32_bf16 v[56:59], a[120:123], v[192:195], v[56:59]
    v_mfma_f32_16x16x32_bf16 v[60:63], a[124:127], v[192:195], v[60:63]
    v_mfma_f32_16x16x32_bf16 v[64:67], a[128:131], v[192:195], v[64:67]
    v_mfma_f32_16x16x32_bf16 v[68:71], a[132:135], v[192:195], v[68:71]
    v_mfma_f32_16x16x32_bf16 v[72:75], a[136:139], v[192:195], v[72:75]
    buffer_load_dwordx4 v[192:195], v34, s[12:15], s67 offen offset:1024 sc1
    s_waitcnt vmcnt(12)
    v_mfma_f32_16x16x32_bf16 v[76:79], a[204:207], v[196:199], v[76:79]
    v_mfma_f32_16x16x32_bf16 v[80:83], a[208:211], v[196:199], v[80:83]
    v_mfma_f32_16x16x32_bf16 v[84:87], a[212:215], v[196:199], v[84:87]
    v_mfma_f32_16x16x32_bf16 v[88:91], a[216:219], v[196:199], v[88:91]
    ds_write_b128 v23, v[56:59] offset:0
    v_mfma_f32_16x16x32_bf16 v[92:95], a[220:223], v[196:199], v[92:95]
    buffer_load_dwordx4 v[196:199], v34, s[12:15], s67 offen offset:2048 sc1
    v_mfma_f32_16x16x32_bf16 v[76:79], a[60:63], v[200:203], v[76:79]
    v_mfma_f32_16x16x32_bf16 v[80:83], a[64:67], v[200:203], v[80:83]
    v_mfma_f32_16x16x32_bf16 v[84:87], a[68:71], v[200:203], v[84:87]
    ds_write_b128 v23, v[60:63] offset:1024
    v_mfma_f32_16x16x32_bf16 v[88:91], a[72:75], v[200:203], v[88:91]
    v_mfma_f32_16x16x32_bf16 v[92:95], a[76:79], v[200:203], v[92:95]
    buffer_load_dwordx4 v[200:203], v34, s[12:15], s67 offen offset:3072 sc1
    s_waitcnt vmcnt(12)
    v_mfma_f32_16x16x32_bf16 v[76:79], a[160:163], v[204:207], v[76:79]
    v_mfma_f32_16x16x32_bf16 v[80:83], a[164:167], v[204:207], v[80:83]
    ds_write_b128 v23, v[64:67] offset:2048
    v_mfma_f32_16x16x32_bf16 v[84:87], a[168:171], v[204:207], v[84:87]
    v_mfma_f32_16x16x32_bf16 v[88:91], a[172:175], v[204:207], v[88:91]
    v_mfma_f32_16x16x32_bf16 v[92:95], a[176:179], v[204:207], v[92:95]
    buffer_load_dwordx4 v[204:207], v35, s[12:15], s67 offen offset:0 sc1
    v_mfma_f32_16x16x32_bf16 v[76:79], a[80:83], v[208:211], v[76:79]
    ds_write_b128 v23, v[68:71] offset:3072
    v_mfma_f32_16x16x32_bf16 v[80:83], a[84:87], v[208:211], v[80:83]
    v_mfma_f32_16x16x32_bf16 v[84:87], a[88:91], v[208:211], v[84:87]
    v_mfma_f32_16x16x32_bf16 v[88:91], a[92:95], v[208:211], v[88:91]
    v_mfma_f32_16x16x32_bf16 v[92:95], a[96:99], v[208:211], v[92:95]
    buffer_load_dwordx4 v[208:211], v35, s[12:15], s67 offen offset:1024 sc1
    ds_write_b128 v23, v[72:75] offset:4096
    s_waitcnt vmcnt(12)
    v_mfma_f32_16x16x32_bf16 v[76:79], a[100:103], v[212:215], v[76:79]
    v_mfma_f32_16x16x32_bf16 v[80:83], a[104:107], v[212:215], v[80:83]
    v_mfma_f32_16x16x32_bf16 v[84:87], a[108:111], v[212:215], v[84:87]
    v_mfma_f32_16x16x32_bf16 v[88:91], a[112:115], v[212:215], v[88:91]
    v_mfma_f32_16x16x32_bf16 v[92:95], a[116:119], v[212:215], v[92:95]
    s_add_u32 s67, s78, s21
    buffer_load_dwordx4 v[212:215], v34, s[12:15], s67 offen offset:0 sc1
    v_mfma_f32_16x16x32_bf16 v[76:79], a[120:123], v[216:219], v[76:79]
    v_mfma_f32_16x16x32_bf16 v[80:83], a[124:127], v[216:219], v[80:83]
    v_mfma_f32_16x16x32_bf16 v[84:87], a[128:131], v[216:219], v[84:87]
    v_mfma_f32_16x16x32_bf16 v[88:91], a[132:135], v[216:219], v[88:91]
    v_mfma_f32_16x16x32_bf16 v[92:95], a[136:139], v[216:219], v[92:95]
    buffer_load_dwordx4 v[216:219], v34, s[12:15], s67 offen offset:1024 sc1
    s_waitcnt vmcnt(12)
    v_mfma_f32_16x16x32_bf16 v[96:99], a[204:207], v[220:223], v[96:99]
    v_mfma_f32_16x16x32_bf16 v[100:103], a[208:211], v[220:223], v[100:103]
    v_mfma_f32_16x16x32_bf16 v[104:107], a[212:215], v[220:223], v[104:107]
    v_mfma_f32_16x16x32_bf16 v[108:111], a[216:219], v[220:223], v[108:111]
    ds_write_b128 v24, v[76:79] offset:5120
    v_mfma_f32_16x16x32_bf16 v[112:115], a[220:223], v[220:223], v[112:115]
    buffer_load_dwordx4 v[220:223], v34, s[12:15], s67 offen offset:2048 sc1
    v_mfma_f32_16x16x32_bf16 v[96:99], a[60:63], v[224:227], v[96:99]
    v_mfma_f32_16x16x32_bf16 v[100:103], a[64:67], v[224:227], v[100:103]
    v_mfma_f32_16x16x32_bf16 v[104:107], a[68:71], v[224:227], v[104:107]
    ds_write_b128 v24, v[80:83] offset:6144
    v_mfma_f32_16x16x32_bf16 v[108:111], a[72:75], v[224:227], v[108:111]
    v_mfma_f32_16x16x32_bf16 v[112:115], a[76:79], v[224:227], v[112:115]
    buffer_load_dwordx4 v[224:227], v34, s[12:15], s67 offen offset:3072 sc1
    s_waitcnt vmcnt(12)
    v_mfma_f32_16x16x32_bf16 v[96:99], a[160:163], a[140:143], v[96:99]
    v_mfma_f32_16x16x32_bf16 v[100:103], a[164:167], a[140:143], v[100:103]
    ds_write_b128 v24, v[84:87] offset:7168
    v_mfma_f32_16x16x32_bf16 v[104:107], a[168:171], a[140:143], v[104:107]
    v_mfma_f32_16x16x32_bf16 v[108:111], a[172:175], a[140:143], v[108:111]
    v_mfma_f32_16x16x32_bf16 v[112:115], a[176:179], a[140:143], v[112:115]
    buffer_load_dwordx4 a[140:143], v35, s[12:15], s67 offen offset:0 sc1
    v_mfma_f32_16x16x32_bf16 v[96:99], a[80:83], a[144:147], v[96:99]
    ds_write_b128 v24, v[88:91] offset:8192
    v_mfma_f32_16x16x32_bf16 v[100:103], a[84:87], a[144:147], v[100:103]
    v_mfma_f32_16x16x32_bf16 v[104:107], a[88:91], a[144:147], v[104:107]
    v_mfma_f32_16x16x32_bf16 v[108:111], a[92:95], a[144:147], v[108:111]
    v_mfma_f32_16x16x32_bf16 v[112:115], a[96:99], a[144:147], v[112:115]
    buffer_load_dwordx4 a[144:147], v35, s[12:15], s67 offen offset:1024 sc1
    ds_write_b128 v24, v[92:95] offset:9216
    s_waitcnt vmcnt(12)
    v_mfma_f32_16x16x32_bf16 v[96:99], a[100:103], v[180:183], v[96:99]
    v_mfma_f32_16x16x32_bf16 v[100:103], a[104:107], v[180:183], v[100:103]
    v_mfma_f32_16x16x32_bf16 v[104:107], a[108:111], v[180:183], v[104:107]
    v_mfma_f32_16x16x32_bf16 v[108:111], a[112:115], v[180:183], v[108:111]
    v_mfma_f32_16x16x32_bf16 v[112:115], a[116:119], v[180:183], v[112:115]
    s_add_u32 s67, s78, s22
    buffer_load_dwordx4 v[180:183], v34, s[12:15], s67 offen offset:0 sc1
    v_mfma_f32_16x16x32_bf16 v[96:99], a[120:123], v[184:187], v[96:99]
    v_mfma_f32_16x16x32_bf16 v[100:103], a[124:127], v[184:187], v[100:103]
    v_mfma_f32_16x16x32_bf16 v[104:107], a[128:131], v[184:187], v[104:107]
    v_mfma_f32_16x16x32_bf16 v[108:111], a[132:135], v[184:187], v[108:111]
    v_mfma_f32_16x16x32_bf16 v[112:115], a[136:139], v[184:187], v[112:115]
    buffer_load_dwordx4 v[184:187], v34, s[12:15], s67 offen offset:1024 sc1
    s_waitcnt vmcnt(12)
    v_mfma_f32_16x16x32_bf16 v[36:39], a[204:207], v[188:191], v[36:39]
    v_mfma_f32_16x16x32_bf16 v[40:43], a[208:211], v[188:191], v[40:43]
    v_mfma_f32_16x16x32_bf16 v[44:47], a[212:215], v[188:191], v[44:47]
    v_mfma_f32_16x16x32_bf16 v[48:51], a[216:219], v[188:191], v[48:51]
    ds_write_b128 v25, v[96:99] offset:10240
    v_mfma_f32_16x16x32_bf16 v[52:55], a[220:223], v[188:191], v[52:55]
    buffer_load_dwordx4 v[188:191], v34, s[12:15], s67 offen offset:2048 sc1
    ds_write_b128 v25, v[100:103] offset:11264
    v_mfma_f32_16x16x32_bf16 v[36:39], a[60:63], v[192:195], v[36:39]
    v_mfma_f32_16x16x32_bf16 v[40:43], a[64:67], v[192:195], v[40:43]
    ds_write_b128 v25, v[104:107] offset:12288
    v_mfma_f32_16x16x32_bf16 v[44:47], a[68:71], v[192:195], v[44:47]
    v_mfma_f32_16x16x32_bf16 v[48:51], a[72:75], v[192:195], v[48:51]
    ds_write_b128 v25, v[108:111] offset:13312
    v_mfma_f32_16x16x32_bf16 v[52:55], a[76:79], v[192:195], v[52:55]
    buffer_load_dwordx4 v[192:195], v34, s[12:15], s67 offen offset:3072 sc1
    s_waitcnt vmcnt(12)
    v_mfma_f32_16x16x32_bf16 v[36:39], a[160:163], v[196:199], v[36:39]
    ds_write_b128 v25, v[112:115] offset:14336
    v_mfma_f32_16x16x32_bf16 v[40:43], a[164:167], v[196:199], v[40:43]
    v_mfma_f32_16x16x32_bf16 v[44:47], a[168:171], v[196:199], v[44:47]
    v_mfma_f32_16x16x32_bf16 v[48:51], a[172:175], v[196:199], v[48:51]
    v_mfma_f32_16x16x32_bf16 v[52:55], a[176:179], v[196:199], v[52:55]
    buffer_load_dwordx4 v[196:199], v35, s[12:15], s67 offen offset:0 sc1
    s_waitcnt lgkmcnt(0)
    s_barrier
    ds_read_b128 v[56:59], v22 offset:0
    v_mfma_f32_16x16x32_bf16 v[36:39], a[80:83], v[200:203], v[36:39]
    ds_read_b128 v[76:79], v22 offset:5120
    v_mfma_f32_16x16x32_bf16 v[40:43], a[84:87], v[200:203], v[40:43]
    ds_read_b128 v[96:99], v22 offset:10240
    v_mfma_f32_16x16x32_bf16 v[44:47], a[88:91], v[200:203], v[44:47]
    ds_read_b128 v[60:63], v22 offset:1024
    v_mfma_f32_16x16x32_bf16 v[48:51], a[92:95], v[200:203], v[48:51]
    ds_read_b128 v[80:83], v22 offset:6144
    v_mfma_f32_16x16x32_bf16 v[52:55], a[96:99], v[200:203], v[52:55]
    buffer_load_dwordx4 v[200:203], v35, s[12:15], s67 offen offset:1024 sc1
    ds_read_b128 v[100:103], v22 offset:11264
    s_waitcnt vmcnt(12)
    v_mfma_f32_16x16x32_bf16 v[36:39], a[100:103], v[204:207], v[36:39]
    ds_read_b128 v[64:67], v22 offset:2048
    v_mfma_f32_16x16x32_bf16 v[40:43], a[104:107], v[204:207], v[40:43]
    ds_read_b128 v[84:87], v22 offset:7168
    v_mfma_f32_16x16x32_bf16 v[44:47], a[108:111], v[204:207], v[44:47]
    ds_read_b128 v[104:107], v22 offset:12288
    v_mfma_f32_16x16x32_bf16 v[48:51], a[112:115], v[204:207], v[48:51]
    ds_read_b128 v[68:71], v22 offset:3072
    v_mfma_f32_16x16x32_bf16 v[52:55], a[116:119], v[204:207], v[52:55]
    s_add_u32 s67, s78, s23
    buffer_load_dwordx4 v[204:207], v34, s[12:15], s67 offen offset:0 sc1
    ds_read_b128 v[88:91], v22 offset:8192
    v_mfma_f32_16x16x32_bf16 v[36:39], a[120:123], v[208:211], v[36:39]
    ds_read_b128 v[108:111], v22 offset:13312
    v_mfma_f32_16x16x32_bf16 v[40:43], a[124:127], v[208:211], v[40:43]
    ds_read_b128 v[72:75], v22 offset:4096
    v_mfma_f32_16x16x32_bf16 v[44:47], a[128:131], v[208:211], v[44:47]
    ds_read_b128 v[92:95], v22 offset:9216
    v_mfma_f32_16x16x32_bf16 v[48:51], a[132:135], v[208:211], v[48:51]
    ds_read_b128 v[112:115], v22 offset:14336
    v_mfma_f32_16x16x32_bf16 v[52:55], a[136:139], v[208:211], v[52:55]
    buffer_load_dwordx4 v[208:211], v34, s[12:15], s67 offen offset:1024 sc1
    s_waitcnt vmcnt(12)
    v_mfma_f32_16x16x32_bf16 v[116:119], a[204:207], v[212:215], v[116:119]
    v_mfma_f32_16x16x32_bf16 v[120:123], a[208:211], v[212:215], v[120:123]
    v_mfma_f32_16x16x32_bf16 v[124:127], a[212:215], v[212:215], v[124:127]
    v_mfma_f32_16x16x32_bf16 v[128:131], a[216:219], v[212:215], v[128:131]
    s_waitcnt lgkmcnt(0)
    v_pk_add_f32 v[36:37], v[36:37], v[56:57]
    v_mfma_f32_16x16x32_bf16 v[132:135], a[220:223], v[212:215], v[132:135]
    buffer_load_dwordx4 v[212:215], v34, s[12:15], s67 offen offset:2048 sc1
    v_pk_add_f32 v[38:39], v[38:39], v[58:59]
    v_pk_add_f32 v[36:37], v[36:37], v[76:77]
    v_mfma_f32_16x16x32_bf16 v[116:119], a[60:63], v[216:219], v[116:119]
    v_pk_add_f32 v[38:39], v[38:39], v[78:79]
    v_pk_add_f32 v[36:37], v[36:37], v[96:97]
    v_mfma_f32_16x16x32_bf16 v[120:123], a[64:67], v[216:219], v[120:123]
    v_pk_add_f32 v[38:39], v[38:39], v[98:99]
    v_cvt_pk_bf16_f32 v36, v36, v37
    v_mfma_f32_16x16x32_bf16 v[124:127], a[68:71], v[216:219], v[124:127]
    v_cvt_pk_bf16_f32 v37, v38, v39
    v_pk_add_f32 v[40:41], v[40:41], v[60:61]
    v_mfma_f32_16x16x32_bf16 v[128:131], a[72:75], v[216:219], v[128:131]
    v_pk_add_f32 v[42:43], v[42:43], v[62:63]
    v_mfma_f32_16x16x32_bf16 v[132:135], a[76:79], v[216:219], v[132:135]
    buffer_load_dwordx4 v[216:219], v34, s[12:15], s67 offen offset:3072 sc1
    v_pk_add_f32 v[40:41], v[40:41], v[80:81]
    v_pk_add_f32 v[42:43], v[42:43], v[82:83]
    s_waitcnt vmcnt(12)
    v_mfma_f32_16x16x32_bf16 v[116:119], a[160:163], v[220:223], v[116:119]
    v_pk_add_f32 v[40:41], v[40:41], v[100:101]
    v_pk_add_f32 v[42:43], v[42:43], v[102:103]
    v_mfma_f32_16x16x32_bf16 v[120:123], a[164:167], v[220:223], v[120:123]
    v_cvt_pk_bf16_f32 v38, v40, v41
    v_cvt_pk_bf16_f32 v39, v42, v43
    v_mfma_f32_16x16x32_bf16 v[124:127], a[168:171], v[220:223], v[124:127]
    buffer_store_dwordx4 v[36:39], v34, s[12:15], s75 offen offset:0 sc1
    v_pk_add_f32 v[44:45], v[44:45], v[64:65]
    v_mfma_f32_16x16x32_bf16 v[128:131], a[172:175], v[220:223], v[128:131]
    v_pk_add_f32 v[46:47], v[46:47], v[66:67]
    v_pk_add_f32 v[44:45], v[44:45], v[84:85]
    v_mfma_f32_16x16x32_bf16 v[132:135], a[176:179], v[220:223], v[132:135]
    buffer_load_dwordx4 v[220:223], v35, s[12:15], s67 offen offset:0 sc1
    v_pk_add_f32 v[46:47], v[46:47], v[86:87]
    v_mfma_f32_16x16x32_bf16 v[116:119], a[80:83], v[224:227], v[116:119]
    v_pk_add_f32 v[44:45], v[44:45], v[104:105]
    v_pk_add_f32 v[46:47], v[46:47], v[106:107]
    v_mfma_f32_16x16x32_bf16 v[120:123], a[84:87], v[224:227], v[120:123]
    v_cvt_pk_bf16_f32 v40, v44, v45
    v_cvt_pk_bf16_f32 v41, v46, v47
    v_mfma_f32_16x16x32_bf16 v[124:127], a[88:91], v[224:227], v[124:127]
    v_pk_add_f32 v[48:49], v[48:49], v[68:69]
    v_pk_add_f32 v[50:51], v[50:51], v[70:71]
    v_mfma_f32_16x16x32_bf16 v[128:131], a[92:95], v[224:227], v[128:131]
    v_pk_add_f32 v[48:49], v[48:49], v[88:89]
    v_pk_add_f32 v[50:51], v[50:51], v[90:91]
    v_mfma_f32_16x16x32_bf16 v[132:135], a[96:99], v[224:227], v[132:135]
    buffer_load_dwordx4 v[224:227], v35, s[12:15], s67 offen offset:1024 sc1
    v_pk_add_f32 v[48:49], v[48:49], v[108:109]
    v_pk_add_f32 v[50:51], v[50:51], v[110:111]
    s_waitcnt vmcnt(13)
    v_mfma_f32_16x16x32_bf16 v[116:119], a[100:103], a[140:143], v[116:119]
    v_cvt_pk_bf16_f32 v42, v48, v49
    v_mfma_f32_16x16x32_bf16 v[120:123], a[104:107], a[140:143], v[120:123]
    v_cvt_pk_bf16_f32 v43, v50, v51
    buffer_store_dwordx4 v[40:43], v34, s[12:15], s75 offen offset:1024 sc1
    v_mfma_f32_16x16x32_bf16 v[124:127], a[108:111], a[140:143], v[124:127]
    v_pk_add_f32 v[52:53], v[52:53], v[72:73]
    v_pk_add_f32 v[54:55], v[54:55], v[74:75]
    v_mfma_f32_16x16x32_bf16 v[128:131], a[112:115], a[140:143], v[128:131]
    v_pk_add_f32 v[52:53], v[52:53], v[92:93]
    v_pk_add_f32 v[54:55], v[54:55], v[94:95]
    v_mfma_f32_16x16x32_bf16 v[132:135], a[116:119], a[140:143], v[132:135]
    s_add_u32 s67, s78, s20
    buffer_load_dwordx4 a[140:143], v34, s[12:15], s67 offen offset:0 sc1
    v_pk_add_f32 v[52:53], v[52:53], v[112:113]
    v_pk_add_f32 v[54:55], v[54:55], v[114:115]
    v_mfma_f32_16x16x32_bf16 v[116:119], a[120:123], a[144:147], v[116:119]
    v_cvt_pk_bf16_f32 v44, v52, v53
    v_cvt_pk_bf16_f32 v45, v54, v55
    v_mfma_f32_16x16x32_bf16 v[120:123], a[124:127], a[144:147], v[120:123]
    buffer_store_dwordx2 v[44:45], v9, s[12:15], s75 offen offset:2048 sc1
    v_mfma_f32_16x16x32_bf16 v[124:127], a[128:131], a[144:147], v[124:127]
    v_mfma_f32_16x16x32_bf16 v[128:131], a[132:135], a[144:147], v[128:131]
    v_add_u32 v22, 65536, v22
    v_add_u32 v23, 65536, v23
    v_mfma_f32_16x16x32_bf16 v[132:135], a[136:139], a[144:147], v[132:135]
    buffer_load_dwordx4 a[144:147], v34, s[12:15], s67 offen offset:1024 sc1
    v_add_u32 v24, 65536, v24
    v_add_u32 v25, 65536, v25
    s_waitcnt vmcnt(15)
    v_mfma_f32_16x16x32_bf16 v[136:139], a[204:207], v[180:183], v[136:139]
    v_mfma_f32_16x16x32_bf16 v[140:143], a[208:211], v[180:183], v[140:143]
    v_mfma_f32_16x16x32_bf16 v[144:147], a[212:215], v[180:183], v[144:147]
    v_mfma_f32_16x16x32_bf16 v[148:151], a[216:219], v[180:183], v[148:151]
    ds_write_b128 v23, v[116:119] offset:0
    v_mfma_f32_16x16x32_bf16 v[152:155], a[220:223], v[180:183], v[152:155]
    buffer_load_dwordx4 v[180:183], v34, s[12:15], s67 offen offset:2048 sc1
    v_mfma_f32_16x16x32_bf16 v[136:139], a[60:63], v[184:187], v[136:139]
    v_mfma_f32_16x16x32_bf16 v[140:143], a[64:67], v[184:187], v[140:143]
    v_mfma_f32_16x16x32_bf16 v[144:147], a[68:71], v[184:187], v[144:147]
    ds_write_b128 v23, v[120:123] offset:1024
    v_mfma_f32_16x16x32_bf16 v[148:151], a[72:75], v[184:187], v[148:151]
    v_mfma_f32_16x16x32_bf16 v[152:155], a[76:79], v[184:187], v[152:155]
    buffer_load_dwordx4 v[184:187], v34, s[12:15], s67 offen offset:3072 sc1
    s_waitcnt vmcnt(15)
    v_mfma_f32_16x16x32_bf16 v[136:139], a[160:163], v[188:191], v[136:139]
    v_mfma_f32_16x16x32_bf16 v[140:143], a[164:167], v[188:191], v[140:143]
    ds_write_b128 v23, v[124:127] offset:2048
    v_mfma_f32_16x16x32_bf16 v[144:147], a[168:171], v[188:191], v[144:147]
    v_mfma_f32_16x16x32_bf16 v[148:151], a[172:175], v[188:191], v[148:151]
    v_mfma_f32_16x16x32_bf16 v[152:155], a[176:179], v[188:191], v[152:155]
    buffer_load_dwordx4 v[188:191], v35, s[12:15], s67 offen offset:0 sc1
    v_mfma_f32_16x16x32_bf16 v[136:139], a[80:83], v[192:195], v[136:139]
    ds_write_b128 v23, v[128:131] offset:3072
    v_mfma_f32_16x16x32_bf16 v[140:143], a[84:87], v[192:195], v[140:143]
    v_mfma_f32_16x16x32_bf16 v[144:147], a[88:91], v[192:195], v[144:147]
    v_mfma_f32_16x16x32_bf16 v[148:151], a[92:95], v[192:195], v[148:151]
    v_mfma_f32_16x16x32_bf16 v[152:155], a[96:99], v[192:195], v[152:155]
    buffer_load_dwordx4 v[192:195], v35, s[12:15], s67 offen offset:1024 sc1
    ds_write_b128 v23, v[132:135] offset:4096
    s_waitcnt vmcnt(15)
    v_mfma_f32_16x16x32_bf16 v[136:139], a[100:103], v[196:199], v[136:139]
    v_mfma_f32_16x16x32_bf16 v[140:143], a[104:107], v[196:199], v[140:143]
    v_mfma_f32_16x16x32_bf16 v[144:147], a[108:111], v[196:199], v[144:147]
    v_mfma_f32_16x16x32_bf16 v[148:151], a[112:115], v[196:199], v[148:151]
    v_mfma_f32_16x16x32_bf16 v[152:155], a[116:119], v[196:199], v[152:155]
    v_mfma_f32_16x16x32_bf16 v[136:139], a[120:123], v[200:203], v[136:139]
    v_mfma_f32_16x16x32_bf16 v[140:143], a[124:127], v[200:203], v[140:143]
    v_mfma_f32_16x16x32_bf16 v[144:147], a[128:131], v[200:203], v[144:147]
    v_mfma_f32_16x16x32_bf16 v[148:151], a[132:135], v[200:203], v[148:151]
    v_mfma_f32_16x16x32_bf16 v[152:155], a[136:139], v[200:203], v[152:155]
    s_waitcnt vmcnt(13)
    v_mfma_f32_16x16x32_bf16 v[156:159], a[204:207], v[204:207], v[156:159]
    v_mfma_f32_16x16x32_bf16 v[160:163], a[208:211], v[204:207], v[160:163]
    v_mfma_f32_16x16x32_bf16 v[164:167], a[212:215], v[204:207], v[164:167]
    v_mfma_f32_16x16x32_bf16 v[168:171], a[216:219], v[204:207], v[168:171]
    ds_write_b128 v24, v[136:139] offset:5120
    v_mfma_f32_16x16x32_bf16 v[172:175], a[220:223], v[204:207], v[172:175]
    v_mfma_f32_16x16x32_bf16 v[156:159], a[60:63], v[208:211], v[156:159]
    v_mfma_f32_16x16x32_bf16 v[160:163], a[64:67], v[208:211], v[160:163]
    v_mfma_f32_16x16x32_bf16 v[164:167], a[68:71], v[208:211], v[164:167]
    ds_write_b128 v24, v[140:143] offset:6144
    v_mfma_f32_16x16x32_bf16 v[168:171], a[72:75], v[208:211], v[168:171]
    v_mfma_f32_16x16x32_bf16 v[172:175], a[76:79], v[208:211], v[172:175]
    s_waitcnt vmcnt(11)
    v_mfma_f32_16x16x32_bf16 v[156:159], a[160:163], v[212:215], v[156:159]
    v_mfma_f32_16x16x32_bf16 v[160:163], a[164:167], v[212:215], v[160:163]
    ds_write_b128 v24, v[144:147] offset:7168
    v_mfma_f32_16x16x32_bf16 v[164:167], a[168:171], v[212:215], v[164:167]
    v_mfma_f32_16x16x32_bf16 v[168:171], a[172:175], v[212:215], v[168:171]
    v_mfma_f32_16x16x32_bf16 v[172:175], a[176:179], v[212:215], v[172:175]
    v_mfma_f32_16x16x32_bf16 v[156:159], a[80:83], v[216:219], v[156:159]
    ds_write_b128 v24, v[148:151] offset:8192
    v_mfma_f32_16x16x32_bf16 v[160:163], a[84:87], v[216:219], v[160:163]
    v_mfma_f32_16x16x32_bf16 v[164:167], a[88:91], v[216:219], v[164:167]
    v_mfma_f32_16x16x32_bf16 v[168:171], a[92:95], v[216:219], v[168:171]
    v_mfma_f32_16x16x32_bf16 v[172:175], a[96:99], v[216:219], v[172:175]
    ds_write_b128 v24, v[152:155] offset:9216
    s_waitcnt vmcnt(8)
    v_mfma_f32_16x16x32_bf16 v[156:159], a[100:103], v[220:223], v[156:159]
    buffer_load_dwordx4 v[56:59], v34, s[12:15], s77 offen offset:0 sc1
    v_mfma_f32_16x16x32_bf16 v[160:163], a[104:107], v[220:223], v[160:163]
    v_mfma_f32_16x16x32_bf16 v[164:167], a[108:111], v[220:223], v[164:167]
    buffer_load_dwordx4 v[60:63], v34, s[12:15], s77 offen offset:1024 sc1
    v_mfma_f32_16x16x32_bf16 v[168:171], a[112:115], v[220:223], v[168:171]
    v_mfma_f32_16x16x32_bf16 v[172:175], a[116:119], v[220:223], v[172:175]
    buffer_load_dwordx2 v[64:65], v9, s[12:15], s77 offen offset:2048 sc1
    v_mfma_f32_16x16x32_bf16 v[156:159], a[120:123], v[224:227], v[156:159]
    v_mfma_f32_16x16x32_bf16 v[160:163], a[124:127], v[224:227], v[160:163]
    v_mfma_f32_16x16x32_bf16 v[164:167], a[128:131], v[224:227], v[164:167]
    v_mfma_f32_16x16x32_bf16 v[168:171], a[132:135], v[224:227], v[168:171]
    v_mfma_f32_16x16x32_bf16 v[172:175], a[136:139], v[224:227], v[172:175]
    s_waitcnt vmcnt(7)
    v_mfma_f32_16x16x32_bf16 v[232:235], a[204:207], a[140:143], v[232:235]
    v_mfma_f32_16x16x32_bf16 v[236:239], a[208:211], a[140:143], v[236:239]
    v_mfma_f32_16x16x32_bf16 v[240:243], a[212:215], a[140:143], v[240:243]
    v_mfma_f32_16x16x32_bf16 v[244:247], a[216:219], a[140:143], v[244:247]
    ds_write_b128 v25, v[156:159] offset:10240
    v_mfma_f32_16x16x32_bf16 v[176:179], a[220:223], a[140:143], v[176:179]
    ds_write_b128 v25, v[160:163] offset:11264
    v_mfma_f32_16x16x32_bf16 v[232:235], a[60:63], a[144:147], v[232:235]
    v_mfma_f32_16x16x32_bf16 v[236:239], a[64:67], a[144:147], v[236:239]
    ds_write_b128 v25, v[164:167] offset:12288
    v_mfma_f32_16x16x32_bf16 v[240:243], a[68:71], a[144:147], v[240:243]
    v_mfma_f32_16x16x32_bf16 v[244:247], a[72:75], a[144:147], v[244:247]
    ds_write_b128 v25, v[168:171] offset:13312
    v_mfma_f32_16x16x32_bf16 v[176:179], a[76:79], a[144:147], v[176:179]
    s_waitcnt vmcnt(5)
    v_mfma_f32_16x16x32_bf16 v[232:235], a[160:163], v[180:183], v[232:235]
    ds_write_b128 v25, v[172:175] offset:14336
    v_mfma_f32_16x16x32_bf16 v[236:239], a[164:167], v[180:183], v[236:239]
    v_mfma_f32_16x16x32_bf16 v[240:243], a[168:171], v[180:183], v[240:243]
    v_mfma_f32_16x16x32_bf16 v[244:247], a[172:175], v[180:183], v[244:247]
    v_mfma_f32_16x16x32_bf16 v[176:179], a[176:179], v[180:183], v[176:179]
    s_waitcnt lgkmcnt(0)
    s_barrier
    ds_read_b128 v[116:119], v22 offset:0
    ds_read_b128 v[136:139], v22 offset:5120
    v_mfma_f32_16x16x32_bf16 v[232:235], a[80:83], v[184:187], v[232:235]
    ds_read_b128 v[156:159], v22 offset:10240
    ds_read_b128 v[120:123], v22 offset:1024
    v_mfma_f32_16x16x32_bf16 v[236:239], a[84:87], v[184:187], v[236:239]
    ds_read_b128 v[140:143], v22 offset:6144
    ds_read_b128 v[160:163], v22 offset:11264
    v_mfma_f32_16x16x32_bf16 v[240:243], a[88:91], v[184:187], v[240:243]
    ds_read_b128 v[124:127], v22 offset:2048
    ds_read_b128 v[144:147], v22 offset:7168
    v_mfma_f32_16x16x32_bf16 v[244:247], a[92:95], v[184:187], v[244:247]
    ds_read_b128 v[164:167], v22 offset:12288
    ds_read_b128 v[128:131], v22 offset:3072
    v_mfma_f32_16x16x32_bf16 v[176:179], a[96:99], v[184:187], v[176:179]
    ds_read_b128 v[148:151], v22 offset:8192
    ds_read_b128 v[168:171], v22 offset:13312
    s_waitcnt vmcnt(3)
    v_mfma_f32_16x16x32_bf16 v[232:235], a[100:103], v[188:191], v[232:235]
    ds_read_b128 v[132:135], v22 offset:4096
    ds_read_b128 v[152:155], v22 offset:9216
    v_mfma_f32_16x16x32_bf16 v[236:239], a[104:107], v[188:191], v[236:239]
    ds_read_b128 v[172:175], v22 offset:14336
    v_mfma_f32_16x16x32_bf16 v[240:243], a[108:111], v[188:191], v[240:243]
    v_mfma_f32_16x16x32_bf16 v[244:247], a[112:115], v[188:191], v[244:247]
    v_mfma_f32_16x16x32_bf16 v[176:179], a[116:119], v[188:191], v[176:179]
    v_mfma_f32_16x16x32_bf16 v[232:235], a[120:123], v[192:195], v[232:235]
    v_mfma_f32_16x16x32_bf16 v[236:239], a[124:127], v[192:195], v[236:239]
    v_mfma_f32_16x16x32_bf16 v[240:243], a[128:131], v[192:195], v[240:243]
    v_mfma_f32_16x16x32_bf16 v[244:247], a[132:135], v[192:195], v[244:247]
    v_mfma_f32_16x16x32_bf16 v[176:179], a[136:139], v[192:195], v[176:179]
    s_waitcnt lgkmcnt(0)
    v_pk_add_f32 v[116:117], v[116:117], v[136:137]
    v_pk_add_f32 v[118:119], v[118:119], v[138:139]
    v_pk_add_f32 v[116:117], v[116:117], v[156:157]
    v_pk_add_f32 v[118:119], v[118:119], v[158:159]
    v_pk_add_f32 v[120:121], v[120:121], v[140:141]
    v_pk_add_f32 v[122:123], v[122:123], v[142:143]
    v_pk_add_f32 v[120:121], v[120:121], v[160:161]
    v_pk_add_f32 v[122:123], v[122:123], v[162:163]
    v_pk_add_f32 v[124:125], v[124:125], v[144:145]
    v_pk_add_f32 v[126:127], v[126:127], v[146:147]
    v_pk_add_f32 v[124:125], v[124:125], v[164:165]
    v_pk_add_f32 v[126:127], v[126:127], v[166:167]
    v_pk_add_f32 v[128:129], v[128:129], v[148:149]
    v_pk_add_f32 v[130:131], v[130:131], v[150:151]
    v_pk_add_f32 v[128:129], v[128:129], v[168:169]
    v_pk_add_f32 v[130:131], v[130:131], v[170:171]
    v_pk_add_f32 v[132:133], v[132:133], v[152:153]
    v_pk_add_f32 v[134:135], v[134:135], v[154:155]
    v_pk_add_f32 v[132:133], v[132:133], v[172:173]
    v_pk_add_f32 v[134:135], v[134:135], v[174:175]
    s_mov_b32 s32, 0
L_p5:
    s_waitcnt vmcnt(0)
    v_max_u32_e64 v1, v56, v57
    v_max3_u32 v1, v1, v58, v59
    v_max3_u32 v1, v1, v60, v61
    v_max3_u32 v1, v1, v62, v63
    v_max3_u32 v1, v1, v64, v65
    v_cmp_eq_u32 vcc, -1, v1
    s_add_u32 s32, s32, 1
    s_cmp_eq_u64 vcc, 0
    s_cbranch_scc1 L_p5d
    s_cmp_gt_u32 s32, 200000
    s_cbranch_scc1 L_p5d
    buffer_load_dwordx4 v[56:59], v34, s[12:15], s77 offen offset:0 sc1
    buffer_load_dwordx4 v[60:63], v34, s[12:15], s77 offen offset:1024 sc1
    buffer_load_dwordx2 v[64:65], v9, s[12:15], s77 offen offset:2048 sc1
    s_branch L_p5
L_p5d:
    v_lshlrev_b32_e64 v76, 16, v56
    v_and_b32 v77, 0xffff0000, v56
    v_pk_add_f32 v[232:233], v[232:233], v[116:117]
    v_lshlrev_b32_e64 v78, 16, v57
    v_and_b32 v79, 0xffff0000, v57
    v_pk_add_f32 v[234:235], v[234:235], v[118:119]
    v_pk_add_f32 v[232:233], v[232:233], v[76:77]
    v_pk_add_f32 v[234:235], v[234:235], v[78:79]
    buffer_store_dwordx4 v[232:235], v5, s[8:11], 0 offen offset:0 sc1
    v_lshlrev_b32_e64 v80, 16, v58
    v_and_b32 v81, 0xffff0000, v58
    v_pk_add_f32 v[236:237], v[236:237], v[120:121]
    v_lshlrev_b32_e64 v82, 16, v59
    v_and_b32 v83, 0xffff0000, v59
    v_pk_add_f32 v[238:239], v[238:239], v[122:123]
    v_pk_add_f32 v[236:237], v[236:237], v[80:81]
    v_pk_add_f32 v[238:239], v[238:239], v[82:83]
    buffer_store_dwordx4 v[236:239], v5, s[8:11], 0 offen offset:64 sc1
    v_lshlrev_b32_e64 v84, 16, v60
    v_and_b32 v85, 0xffff0000, v60
    v_pk_add_f32 v[240:241], v[240:241], v[124:125]
    v_lshlrev_b32_e64 v86, 16, v61
    v_and_b32 v87, 0xffff0000, v61
    v_pk_add_f32 v[242:243], v[242:243], v[126:127]
    v_pk_add_f32 v[240:241], v[240:241], v[84:85]
    v_pk_add_f32 v[242:243], v[242:243], v[86:87]
    buffer_store_dwordx4 v[240:243], v5, s[8:11], 0 offen offset:128 sc1
    v_lshlrev_b32_e64 v88, 16, v62
    v_and_b32 v89, 0xffff0000, v62
    v_pk_add_f32 v[244:245], v[244:245], v[128:129]
    v_lshlrev_b32_e64 v90, 16, v63
    v_and_b32 v91, 0xffff0000, v63
    v_pk_add_f32 v[246:247], v[246:247], v[130:131]
    v_pk_add_f32 v[244:245], v[244:245], v[88:89]
    v_pk_add_f32 v[246:247], v[246:247], v[90:91]
    buffer_store_dwordx4 v[244:247], v5, s[8:11], 0 offen offset:192 sc1
    v_lshlrev_b32_e64 v92, 16, v64
    v_and_b32 v93, 0xffff0000, v64
    v_pk_add_f32 v[176:177], v[176:177], v[132:133]
    v_lshlrev_b32_e64 v94, 16, v65
    v_and_b32 v95, 0xffff0000, v65
    v_pk_add_f32 v[178:179], v[178:179], v[134:135]
    v_pk_add_f32 v[176:177], v[176:177], v[92:93]
    v_pk_add_f32 v[178:179], v[178:179], v[94:95]
    buffer_store_dwordx4 v[176:179], v5, s[8:11], 0 offen offset:256 sc1
L_end:
    s_endpgm
.section .rodata,"a"
.p2align 6
.amdhsa_kernel parallel_sum__ssm_conv_s5__dense_activation_relu__prompt_kernel
  .amdhsa_next_free_vgpr 512
  .amdhsa_next_free_sgpr 102
  .amdhsa_accum_offset 256
  .amdhsa_group_segment_fixed_size 0
  .amdhsa_kernarg_size 120
  .amdhsa_user_sgpr_count 2
  .amdhsa_user_sgpr_kernarg_segment_ptr 1
  .amdhsa_system_sgpr_workgroup_id_x 1
.end_amdhsa_kernel
```
